```python
import torch

def _softmax(x, axis=-1):
    return torch.softmax(x, dim=axis)
def _gelu(x):
    return torch.nn.functional.gelu(x, approximate="tanh")
def _silu(x):
    return torch.nn.functional.silu(x)
def _sigmoid(x):
    return torch.sigmoid(x)
def _layernorm(x, axis=-1, eps=1e-5):
    m = x.mean(dim=axis, keepdim=True)
    v = x.var(dim=axis, keepdim=True, unbiased=False)
    return (x - m) / torch.sqrt(v + eps)
def _scatter_add(tgt, idx, src, axis=0):
    return tgt.clone().index_add_(axis, idx, src)
def _segment_sum(src, seg, n):
    out = torch.zeros((n,) + src.shape[1:], dtype=src.dtype)
    return out.index_add_(0, seg, src)
def _pad(x, pw):
    flat = tuple(v for pair in reversed(pw) for v in pair)
    return torch.nn.functional.pad(x, flat)

kernel_name = 'sequential_preLN__mha_block_cached__geglu_ffn__decode'

def setup_inputs():

    _w = (lambda a: (lambda t: t.to(torch.bfloat16) if t.is_floating_point() else t)(torch.as_tensor(a)))
    def _A_setup():
        B, Sq, D = 2, 1, 640
        H, Sk, Dh = 32, 8192, 128
        return {
            "x": _w((lambda *s: torch.randn(*s, dtype=torch.bfloat16) * 0.05)(B, Sq, D)),
            "k_cache": _w((lambda *s: torch.randn(*s, dtype=torch.bfloat16) * 3.2)(B, H, Sk, Dh)),
            "v_cache": _w((lambda *s: torch.randn(*s, dtype=torch.bfloat16) * 0.4)(B, H, Sk, Dh)),
            "wq": _w((lambda *s: torch.randn(*s, dtype=torch.bfloat16) * 3.2)(D, H * Dh) * (D ** -0.5)),
            "wo": _w((lambda *s: torch.randn(*s, dtype=torch.bfloat16) * 0.4)(H * Dh, D) * ((H * Dh) ** -0.5)),
        }
    _A_in = _A_setup()

    def _B_setup():
        B, S, D, F = 2, 1, 640, 1728
        return {
            "x": _w((lambda *s: torch.randn(*s, dtype=torch.bfloat16) * 0.05)(B, S, D)),
            "w_gate": _w((lambda *s: torch.randn(*s, dtype=torch.bfloat16) * 0.05)(D, F)),
            "w_up": _w((lambda *s: torch.randn(*s, dtype=torch.bfloat16) * 0.05)(D, F)),
            "w_down": _w((lambda *s: torch.randn(*s, dtype=torch.bfloat16) * 0.05)(F, D)),
        }
    _B_in = _B_setup()

    return {
        "A_x": _A_in["x"],
        "A_k_cache": _A_in["k_cache"],
        "A_v_cache": _A_in["v_cache"],
        "A_wq": _A_in["wq"],
        "A_wo": _A_in["wo"],
        "B_x": _B_in["x"],
        "B_w_gate": _B_in["w_gate"],
        "B_w_up": _B_in["w_up"],
        "B_w_down": _B_in["w_down"],
    }

def reference(A_x, A_k_cache, A_v_cache, A_wq, A_wo, B_x, B_w_gate, B_w_up, B_w_down):
    def _A_ref(x, k_cache, v_cache, wq, wo):
        B, Sq, D = x.shape
        H, Dh = 32, 128
        q = (lambda x, *d: x.permute(*d))((x @ wq).reshape(B, Sq, H, Dh), 0, 2, 1, 3)
        scores = torch.einsum("bhqd,bhkd->bhqk", q, k_cache) * (Dh ** -0.5)
        p = _softmax(scores, axis=-1)
        o = torch.einsum("bhqk,bhkd->bhqd", p, v_cache)
        return (lambda x, *d: x.permute(*d))(o, 0, 2, 1, 3).reshape(B, Sq, H * Dh) @ wo

    def _B_ref(x, w_gate, w_up, w_down):
        return (_gelu(x @ w_gate) * (x @ w_up)) @ w_down

    x = A_x
    h = x + _A_ref(_layernorm(x, axis=-1), A_k_cache, A_v_cache, A_wq, A_wo)
    h2 = h + _B_ref(_layernorm(h, axis=-1), B_w_gate, B_w_up, B_w_down)
    return h2
```

```asm
; @launch grid=(256,1,1) block=(512,1,1) lds=97792
.amdgcn_target "amdgcn-amd-amdhsa--gfx950"
.text
.globl sequential_preLN__mha_block_cached__geglu_ffn__decode_kernel
.p2align 8
.type sequential_preLN__mha_block_cached__geglu_ffn__decode_kernel,@function
sequential_preLN__mha_block_cached__geglu_ffn__decode_kernel:
    s_load_dwordx16 s[16:31], s[0:1], 0
    s_load_dwordx8 s[32:39], s[0:1], 64
    s_cmp_ge_u32 s2, 256
    s_cbranch_scc1 L_end
    v_lshrrev_b32 v1, 6, v0
    v_and_b32 v0, 63, v0
    v_readfirstlane_b32 s3, v1
    s_and_b32 s4, s2, 31
    s_lshr_b32 s5, s2, 5
    s_and_b32 s6, s5, 1
    s_lshr_b32 s7, s5, 1
    v_and_b32 v3, 15, v0
    v_lshrrev_b32 v4, 4, v0
    s_cmp_ge_u32 s3, 4
    s_cbranch_scc1 L_helper
    v_lshrrev_b32 v5, 2, v3
    v_and_b32 v6, 3, v3
    v_lshlrev_b32 v50, 5, v6
    v_lshrrev_b32 v7, 1, v4
    v_lshl_add_u32 v50, v7, 7, v50
    v_and_b32 v7, 1, v4
    v_lshl_add_u32 v50, v7, 4, v50
    v_lshl_add_u32 v1, v5, 8, v50
    s_lshl_b32 s41, s7, 2
    s_add_u32 s41, s41, s3
    s_lshl_b32 s41, s41, 12
    s_and_b32 s57, s4, 16
    s_lshl_b32 s57, s57, 15
    s_xor_b32 s41, s41, s57
    s_mov_b32 s42, s41
    s_lshl_b32 s40, s6, 5
    s_add_u32 s40, s40, s4
    s_lshl_b32 s40, s40, 21
    s_mov_b32 s10, 2097152
    s_mov_b32 s11, 0x20000
    s_mov_b32 s54, 5242880
    s_mov_b32 s55, s11
    s_lshl2_add_u32 s43, s4, s3
    s_mul_i32 s43, s43, 40960
    s_lshl_b32 s50, s5, 8
    s_add_u32 s43, s43, s50
    s_lshl_b32 s50, s3, 13
    s_add_u32 m0, s50, 15872
    v_mul_u32_u24 v51, 1280, v4
    v_lshl_add_u32 v51, v3, 4, v51
    s_movk_i32 s50, 5120
    s_movk_i32 s51, 1024
    s_waitcnt lgkmcnt(0)
    s_add_u32 s8, s18, s40
    s_addc_u32 s9, s19, 0
    s_and_b32 s9, s9, 0xffff
    s_cmp_lt_u32 s5, 5
    s_cbranch_scc0 L_k0
    s_mov_b32 s52, s24
    s_and_b32 s53, s25, 0xffff
    buffer_load_dwordx4 v51, s[52:55], s43 offen nt lds
    s_add_u32 m0, m0, s51
    s_add_u32 s43, s43, s50
    buffer_load_dwordx4 v51, s[52:55], s43 offen nt lds
    s_add_u32 m0, m0, s51
    s_add_u32 s43, s43, s50
    buffer_load_dwordx4 v51, s[52:55], s43 offen nt lds
    s_add_u32 m0, m0, s51
    s_add_u32 s43, s43, s50
    buffer_load_dwordx4 v51, s[52:55], s43 offen nt lds
    s_add_u32 m0, m0, s51
    s_add_u32 s43, s43, s50
    buffer_load_dwordx4 v51, s[52:55], s43 offen nt lds
    s_add_u32 m0, m0, s51
    s_add_u32 s43, s43, s50
    buffer_load_dwordx4 v51, s[52:55], s43 offen nt lds
    s_add_u32 m0, m0, s51
    s_add_u32 s43, s43, s50
    s_waitcnt vmcnt(5)
    buffer_load_dwordx4 v51, s[52:55], s43 offen nt lds
    s_add_u32 m0, m0, s51
    s_add_u32 s43, s43, s50
    s_waitcnt vmcnt(5)
    buffer_load_dwordx4 v51, s[52:55], s43 offen nt lds
L_k0:
    s_waitcnt vmcnt(5)
    buffer_load_dwordx4 v[56:59], v1, s[8:11], s41 offen offset:0 nt
    s_waitcnt vmcnt(5)
    buffer_load_dwordx4 v[60:63], v1, s[8:11], s41 offen offset:1024 nt
    s_waitcnt vmcnt(5)
    buffer_load_dwordx4 v[64:67], v1, s[8:11], s41 offen offset:2048 nt
    s_waitcnt vmcnt(5)
    buffer_load_dwordx4 v[68:71], v1, s[8:11], s41 offen offset:3072 nt
    s_xor_b32 s41, s41, s57
    s_add_u32 s41, s41, 0x10000
    s_xor_b32 s41, s41, s57
    s_waitcnt vmcnt(5)
    buffer_load_dwordx4 v[72:75], v1, s[8:11], s41 offen offset:0 nt
    s_waitcnt vmcnt(5)
    buffer_load_dwordx4 v[76:79], v1, s[8:11], s41 offen offset:1024 nt
    s_branch L_k1
L_helper:
    s_mov_b32 s42, 2097152
    s_mov_b32 s43, 0x20000
    s_mov_b32 s46, 2560
    s_mov_b32 s47, 0x20000
    s_mov_b32 s50, 5242880
    s_mov_b32 s51, 0x20000
    v_lshrrev_b32 v5, 3, v3
    v_and_b32 v6, 7, v3
    v_mul_u32_u24 v7, 1280, v5
    v_lshl_add_u32 v8, v4, 3, v6
    v_lshl_add_u32 v9, v8, 4, v7
    v_lshl_add_u32 v10, v8, 3, v7
    v_mad_u32_u24 v11, v4, 40, v7
    v_min_u32 v13, 4, v6
    v_lshl_add_u32 v11, v13, 3, v11
    v_mul_u32_u24 v13, 163840, v4
    v_lshl_add_u32 v13, v3, 4, v13
    v_mov_b32 v56, 0
    s_mul_i32 s10, s5, 655360
    s_lshl_b32 s11, s4, 8
    s_add_u32 s10, s10, s11
    s_mul_i32 s11, s5, 160
    s_sub_u32 s3, s3, 4
    s_waitcnt lgkmcnt(0)
    s_mov_b32 s40, s38
    s_and_b32 s41, s39, 0xffff
    s_mov_b32 s44, s16
    s_and_b32 s45, s17, 0xffff
    s_mov_b32 s48, s22
    s_and_b32 s49, s23, 0xffff
    s_cmp_eq_u32 s3, 0
    s_cbranch_scc1 L_h0
    s_cmp_eq_u32 s3, 1
    s_cbranch_scc0 L_hset
    v_mov_b32 v8, -1
    v_mov_b32 v9, -1
    v_mov_b32 v10, -1
    v_mov_b32 v11, -1
    s_cmp_lt_u32 s2, 129
    s_cbranch_scc0 L_hset
    s_lshl_b32 s10, s2, 12
    s_add_u32 s10, s10, 1376256
    v_lshlrev_b32 v7, 4, v0
    buffer_store_dwordx4 v[8:11], v7, s[40:43], s10 offen offset:0 sc1
    buffer_store_dwordx4 v[8:11], v7, s[40:43], s10 offen offset:1024 sc1
    buffer_store_dwordx4 v[8:11], v7, s[40:43], s10 offen offset:2048 sc1
    buffer_store_dwordx4 v[8:11], v7, s[40:43], s10 offen offset:3072 sc1
    s_branch L_hset
L_h0:
    s_setprio 3
    buffer_load_dwordx4 v[24:27], v9, s[44:47], 0 offen
    buffer_load_dwordx4 v[28:31], v9, s[44:47], 0 offen offset:512
    buffer_load_dwordx2 v[32:33], v10, s[44:47], 0 offen offset:1024
    buffer_load_dwordx2 v[34:35], v11, s[44:47], s11 offen
    buffer_load_dwordx4 v[96:99], v13, s[48:51], s10 offen nt
    s_add_u32 s10, s10, 8192
    buffer_load_dwordx4 v[100:103], v13, s[48:51], s10 offen nt
    s_add_u32 s10, s10, 8192
    buffer_load_dwordx4 v[104:107], v13, s[48:51], s10 offen nt
    s_add_u32 s10, s10, 8192
    buffer_load_dwordx4 v[108:111], v13, s[48:51], s10 offen nt
    s_add_u32 s10, s10, 8192
    buffer_load_dwordx4 v[112:115], v13, s[48:51], s10 offen nt
    s_add_u32 s10, s10, 8192
    buffer_load_dwordx4 v[116:119], v13, s[48:51], s10 offen nt
    s_add_u32 s10, s10, 8192
    buffer_load_dwordx4 v[120:123], v13, s[48:51], s10 offen nt
    s_add_u32 s10, s10, 8192
    buffer_load_dwordx4 v[124:127], v13, s[48:51], s10 offen nt
    s_add_u32 s10, s10, 8192
    buffer_load_dwordx4 v[128:131], v13, s[48:51], s10 offen nt
    s_add_u32 s10, s10, 8192
    buffer_load_dwordx4 v[132:135], v13, s[48:51], s10 offen nt
    s_add_u32 s10, s10, 8192
    buffer_load_dwordx4 v[136:139], v13, s[48:51], s10 offen nt
    s_add_u32 s10, s10, 8192
    buffer_load_dwordx4 v[140:143], v13, s[48:51], s10 offen nt
    s_add_u32 s10, s10, 8192
    buffer_load_dwordx4 v[144:147], v13, s[48:51], s10 offen nt
    s_add_u32 s10, s10, 8192
    buffer_load_dwordx4 v[148:151], v13, s[48:51], s10 offen nt
    s_add_u32 s10, s10, 8192
    buffer_load_dwordx4 v[152:155], v13, s[48:51], s10 offen nt
    s_add_u32 s10, s10, 8192
    buffer_load_dwordx4 v[156:159], v13, s[48:51], s10 offen nt
    s_add_u32 s10, s10, 8192
    buffer_load_dwordx4 v[160:163], v13, s[48:51], s10 offen nt
    s_add_u32 s10, s10, 8192
    buffer_load_dwordx4 v[164:167], v13, s[48:51], s10 offen nt
    s_add_u32 s10, s10, 8192
    buffer_load_dwordx4 v[168:171], v13, s[48:51], s10 offen nt
    s_add_u32 s10, s10, 8192
    buffer_load_dwordx4 v[172:175], v13, s[48:51], s10 offen nt
    s_branch L_hset
L_k1:
    s_add_u32 s12, s20, s40
    s_addc_u32 s13, s21, 0
    s_and_b32 s13, s13, 0xffff
    s_mov_b32 s14, 2097152
    s_mov_b32 s15, 0x20000
    v_lshlrev_b32 v2, 4, v0
    s_mov_b32 s44, 0x3db504f3
    s_mov_b32 s45, 0x3db504f3
    s_mov_b32 s46, 0x3fb8aa3b
    s_mov_b32 s56, 0xffff0000
    v_and_b32 v6, 1, v3
    v_lshlrev_b32 v6, 4, v6
    v_mov_b32 v7, 0xffff
    v_lshlrev_b32 v7, v6, v7
    v_lshrrev_b32 v6, 1, v3
    v_cmp_eq_u32 vcc, 0, v6
    s_nop 1
    v_cndmask_b32 v8, 0, v7, vcc
    v_cmp_eq_u32 vcc, 1, v6
    s_nop 1
    v_cndmask_b32 v9, 0, v7, vcc
    v_cmp_eq_u32 vcc, 2, v6
    s_nop 1
    v_cndmask_b32 v10, 0, v7, vcc
    v_cmp_eq_u32 vcc, 3, v6
    s_nop 1
    v_cndmask_b32 v11, 0, v7, vcc
    v_mov_b32 v32, 0
    v_mov_b32 v33, 0
    v_mov_b32 v34, 0
    v_mov_b32 v35, 0
    v_mov_b32 v54, 0
    v_mov_b32 v55, 255
    v_lshlrev_b32 v6, 3, v4
    v_add_u32 v6, v6, v3
    v_lshlrev_b32 v6, 4, v6
    s_lshl_b32 s47, s3, 9
    s_add_u32 s47, s47, 512
    v_add_u32 v6, s47, v6
    s_lshl_b32 s47, s3, 3
    s_add_u32 s47, s47, 256
    v_mov_b32 v7, s47
    s_lshl_b32 s47, s3, 11
    s_add_u32 s47, s47, 7680
    v_lshl_add_u32 v53, v4, 4, s47
    v_lshl_add_u32 v52, v5, 2, v53
    v_subrev_u32 v52, 64, v52
    s_waitcnt vmcnt(5)
    buffer_load_dwordx4 v[80:83], v1, s[8:11], s41 offen offset:2048 nt
    s_waitcnt vmcnt(5)
    buffer_load_dwordx4 v[84:87], v1, s[8:11], s41 offen offset:3072 nt
    s_xor_b32 s41, s41, s57
    s_add_u32 s41, s41, 0x10000
    s_xor_b32 s41, s41, s57
    s_waitcnt vmcnt(5)
    buffer_load_dwordx4 v[88:91], v1, s[8:11], s41 offen offset:0 nt
    s_waitcnt vmcnt(5)
    buffer_load_dwordx4 v[92:95], v1, s[8:11], s41 offen offset:1024 nt
    s_waitcnt vmcnt(5)
    buffer_load_dwordx4 v[96:99], v1, s[8:11], s41 offen offset:2048 nt
    s_waitcnt vmcnt(5)
    buffer_load_dwordx4 v[100:103], v1, s[8:11], s41 offen offset:3072 nt
    s_xor_b32 s41, s41, s57
    s_add_u32 s41, s41, 0x10000
    s_xor_b32 s41, s41, s57
    s_waitcnt vmcnt(5)
    buffer_load_dwordx4 v[104:107], v1, s[8:11], s41 offen offset:0 nt
    s_waitcnt vmcnt(5)
    buffer_load_dwordx4 v[108:111], v1, s[8:11], s41 offen offset:1024 nt
    s_waitcnt vmcnt(5)
    buffer_load_dwordx4 v[112:115], v1, s[8:11], s41 offen offset:2048 nt
    s_waitcnt vmcnt(5)
    buffer_load_dwordx4 v[116:119], v1, s[8:11], s41 offen offset:3072 nt
    s_xor_b32 s41, s41, s57
    s_add_u32 s41, s41, 0x10000
    s_xor_b32 s41, s41, s57
    s_waitcnt vmcnt(5)
    buffer_load_dwordx4 v[120:123], v1, s[8:11], s41 offen offset:0 nt
    s_waitcnt vmcnt(5)
    buffer_load_dwordx4 v[124:127], v1, s[8:11], s41 offen offset:1024 nt
    s_waitcnt vmcnt(5)
    buffer_load_dwordx4 v[128:131], v1, s[8:11], s41 offen offset:2048 nt
    s_waitcnt vmcnt(5)
    buffer_load_dwordx4 v[132:135], v1, s[8:11], s41 offen offset:3072 nt
    s_xor_b32 s41, s41, s57
    s_add_u32 s41, s41, 0x10000
    s_xor_b32 s41, s41, s57
    s_waitcnt vmcnt(5)
    buffer_load_dwordx4 v[136:139], v1, s[8:11], s41 offen offset:0 nt
    s_waitcnt vmcnt(5)
    buffer_load_dwordx4 v[140:143], v1, s[8:11], s41 offen offset:1024 nt
    s_waitcnt vmcnt(5)
    buffer_load_dwordx4 v[144:147], v1, s[8:11], s41 offen offset:2048 nt
    s_waitcnt vmcnt(5)
    buffer_load_dwordx4 v[148:151], v1, s[8:11], s41 offen offset:3072 nt
    s_xor_b32 s41, s41, s57
    s_add_u32 s41, s41, 0x10000
    s_xor_b32 s41, s41, s57
    s_waitcnt vmcnt(5)
    buffer_load_dwordx4 v[152:155], v1, s[8:11], s41 offen offset:0 nt
    s_waitcnt vmcnt(5)
    buffer_load_dwordx4 v[156:159], v1, s[8:11], s41 offen offset:1024 nt
    s_waitcnt vmcnt(5)
    buffer_load_dwordx4 v[160:163], v1, s[8:11], s41 offen offset:2048 nt
    s_waitcnt vmcnt(5)
    buffer_load_dwordx4 v[164:167], v1, s[8:11], s41 offen offset:3072 nt
    s_xor_b32 s41, s41, s57
    s_add_u32 s41, s41, 0x10000
    s_xor_b32 s41, s41, s57
    s_waitcnt vmcnt(5)
    buffer_load_dwordx4 v[168:171], v1, s[8:11], s41 offen offset:0 nt
    s_waitcnt vmcnt(5)
    buffer_load_dwordx4 v[172:175], v1, s[8:11], s41 offen offset:1024 nt
    s_waitcnt vmcnt(5)
    buffer_load_dwordx4 v[176:179], v1, s[8:11], s41 offen offset:2048 nt
    s_waitcnt vmcnt(5)
    buffer_load_dwordx4 v[180:183], v1, s[8:11], s41 offen offset:3072 nt
    s_xor_b32 s41, s41, s57
    s_add_u32 s41, s41, 0x10000
    s_xor_b32 s41, s41, s57
    s_waitcnt vmcnt(5)
    buffer_load_dwordx4 v[184:187], v1, s[8:11], s41 offen offset:0 nt
    s_waitcnt vmcnt(5)
    buffer_load_dwordx4 v[188:191], v1, s[8:11], s41 offen offset:1024 nt
    s_waitcnt vmcnt(5)
    buffer_load_dwordx4 v[192:195], v1, s[8:11], s41 offen offset:2048 nt
    s_waitcnt vmcnt(5)
    buffer_load_dwordx4 v[196:199], v1, s[8:11], s41 offen offset:3072 nt
    s_xor_b32 s41, s41, s57
    s_add_u32 s41, s41, 0x10000
    s_xor_b32 s41, s41, s57
    s_waitcnt vmcnt(5)
    buffer_load_dwordx4 v[200:203], v1, s[8:11], s41 offen offset:0 nt
    s_waitcnt vmcnt(5)
    buffer_load_dwordx4 v[204:207], v1, s[8:11], s41 offen offset:1024 nt
    s_waitcnt vmcnt(5)
    buffer_load_dwordx4 v[208:211], v1, s[8:11], s41 offen offset:2048 nt
    s_waitcnt vmcnt(5)
    buffer_load_dwordx4 v[212:215], v1, s[8:11], s41 offen offset:3072 nt
    s_xor_b32 s41, s41, s57
    s_add_u32 s41, s41, 0x10000
    s_xor_b32 s41, s41, s57
    s_waitcnt vmcnt(5)
    buffer_load_dwordx4 v[216:219], v1, s[8:11], s41 offen offset:0 nt
    s_waitcnt vmcnt(5)
    buffer_load_dwordx4 v[220:223], v1, s[8:11], s41 offen offset:1024 nt
    s_waitcnt vmcnt(5)
    buffer_load_dwordx4 v[224:227], v1, s[8:11], s41 offen offset:2048 nt
    s_waitcnt vmcnt(5)
    buffer_load_dwordx4 v[228:231], v1, s[8:11], s41 offen offset:3072 nt
    s_xor_b32 s41, s41, s57
    s_add_u32 s41, s41, 0x10000
    s_xor_b32 s41, s41, s57
    s_waitcnt vmcnt(5)
    buffer_load_dwordx4 v[232:235], v1, s[8:11], s41 offen offset:0 nt
    s_waitcnt vmcnt(5)
    buffer_load_dwordx4 v[236:239], v1, s[8:11], s41 offen offset:1024 nt
    s_waitcnt vmcnt(5)
    buffer_load_dwordx4 v[240:243], v1, s[8:11], s41 offen offset:2048 nt
    s_waitcnt vmcnt(5)
    buffer_load_dwordx4 v[244:247], v1, s[8:11], s41 offen offset:3072 nt
    s_xor_b32 s41, s41, s57
    s_add_u32 s41, s41, 0x10000
    s_xor_b32 s41, s41, s57
    s_barrier
    ds_read_b128 v[36:39], v50 offset:0
    v_cmp_eq_u32 s[48:49], 0, v5
    v_cmp_eq_u32 s[50:51], 1, v5
    v_cmp_eq_u32 s[52:53], 2, v5
    v_cmp_eq_u32 s[54:55], 3, v5
    s_waitcnt lgkmcnt(0)
    v_cndmask_b32 v12, 0, v36, s[48:49]
    v_cndmask_b32 v13, 0, v37, s[48:49]
    v_cndmask_b32 v14, 0, v38, s[48:49]
    v_cndmask_b32 v15, 0, v39, s[48:49]
    v_cndmask_b32 v16, 0, v36, s[50:51]
    v_cndmask_b32 v17, 0, v37, s[50:51]
    v_cndmask_b32 v18, 0, v38, s[50:51]
    v_cndmask_b32 v19, 0, v39, s[50:51]
    v_cndmask_b32 v20, 0, v36, s[52:53]
    v_cndmask_b32 v21, 0, v37, s[52:53]
    v_cndmask_b32 v22, 0, v38, s[52:53]
    v_cndmask_b32 v23, 0, v39, s[52:53]
    v_cndmask_b32 v24, 0, v36, s[54:55]
    v_cndmask_b32 v25, 0, v37, s[54:55]
    v_cndmask_b32 v26, 0, v38, s[54:55]
    v_cndmask_b32 v27, 0, v39, s[54:55]
    s_mov_b32 s48, 0x88888888
    s_mov_b32 s49, 0x88888888
    v_add_u32 v5, s47, v2
    v_mov_b32 v3, 0
    v_mov_b32 v4, 1
    s_mov_b32 s50, 255
    s_and_b32 s52, s2, 7
    s_mul_i32 s52, s52, 12
    s_lshr_b32 s53, s2, 3
    s_add_u32 s52, s52, s53
    s_cmp_lt_u32 s52, 60
    s_cselect_b32 s51, 0, 4
    s_cmp_lt_u32 s2, 160
    s_cselect_b32 s51, 0, s51
    v_mfma_f32_16x16x32_bf16 v[28:31], v[56:59], v[12:15], 0
    v_mfma_f32_16x16x32_bf16 v[28:31], v[60:63], v[16:19], v[28:31]
    v_mfma_f32_16x16x32_bf16 v[28:31], v[64:67], v[20:23], v[28:31]
    v_mfma_f32_16x16x32_bf16 v[28:31], v[68:71], v[24:27], v[28:31]
    v_add_u32 v52, 64, v52
    s_nop 6
    v_add_f32_dpp v50, v28, v29 quad_perm:[0,0,0,0] row_mask:0xf bank_mask:0xf
    v_add_f32_dpp v51, v30, v31 quad_perm:[2,2,2,2] row_mask:0xf bank_mask:0xf
    s_nop 1
    v_add_f32_dpp v50, v50, v51 quad_perm:[1,1,1,1] row_mask:0xf bank_mask:0xf
    s_mov_b64 exec, s[48:49]
    ds_write_b32 v52, v50
    s_mov_b64 exec, -1
    s_waitcnt vmcnt(5)
    buffer_load_dwordx4 v[56:59], v1, s[8:11], s41 offen offset:0 nt
    s_waitcnt vmcnt(5)
    buffer_load_dwordx4 v[60:63], v1, s[8:11], s41 offen offset:1024 nt
    s_waitcnt vmcnt(5)
    buffer_load_dwordx4 v[64:67], v1, s[8:11], s41 offen offset:2048 nt
    s_waitcnt vmcnt(5)
    buffer_load_dwordx4 v[68:71], v1, s[8:11], s41 offen offset:3072 nt
    s_xor_b32 s41, s41, s57
    s_add_u32 s41, s41, 0x10000
    s_xor_b32 s41, s41, s57
    v_mfma_f32_16x16x32_bf16 v[28:31], v[72:75], v[12:15], 0
    v_mfma_f32_16x16x32_bf16 v[28:31], v[76:79], v[16:19], v[28:31]
    v_mfma_f32_16x16x32_bf16 v[28:31], v[80:83], v[20:23], v[28:31]
    v_mfma_f32_16x16x32_bf16 v[28:31], v[84:87], v[24:27], v[28:31]
    v_add_u32 v52, 64, v52
    s_nop 6
    v_add_f32_dpp v50, v28, v29 quad_perm:[0,0,0,0] row_mask:0xf bank_mask:0xf
    v_add_f32_dpp v51, v30, v31 quad_perm:[2,2,2,2] row_mask:0xf bank_mask:0xf
    s_nop 1
    v_add_f32_dpp v50, v50, v51 quad_perm:[1,1,1,1] row_mask:0xf bank_mask:0xf
    s_mov_b64 exec, s[48:49]
    ds_write_b32 v52, v50
    s_mov_b64 exec, -1
    v_mfma_f32_16x16x32_bf16 v[28:31], v[88:91], v[12:15], 0
    v_mfma_f32_16x16x32_bf16 v[28:31], v[92:95], v[16:19], v[28:31]
    v_mfma_f32_16x16x32_bf16 v[28:31], v[96:99], v[20:23], v[28:31]
    v_mfma_f32_16x16x32_bf16 v[28:31], v[100:103], v[24:27], v[28:31]
    v_add_u32 v52, 64, v52
    s_nop 6
    v_add_f32_dpp v50, v28, v29 quad_perm:[0,0,0,0] row_mask:0xf bank_mask:0xf
    v_add_f32_dpp v51, v30, v31 quad_perm:[2,2,2,2] row_mask:0xf bank_mask:0xf
    s_nop 1
    v_add_f32_dpp v50, v50, v51 quad_perm:[1,1,1,1] row_mask:0xf bank_mask:0xf
    s_mov_b64 exec, s[48:49]
    ds_write_b32 v52, v50
    s_mov_b64 exec, -1
    v_mfma_f32_16x16x32_bf16 v[28:31], v[104:107], v[12:15], 0
    v_mfma_f32_16x16x32_bf16 v[28:31], v[108:111], v[16:19], v[28:31]
    v_mfma_f32_16x16x32_bf16 v[28:31], v[112:115], v[20:23], v[28:31]
    v_mfma_f32_16x16x32_bf16 v[28:31], v[116:119], v[24:27], v[28:31]
    v_add_u32 v52, 64, v52
    s_nop 6
    v_add_f32_dpp v50, v28, v29 quad_perm:[0,0,0,0] row_mask:0xf bank_mask:0xf
    v_add_f32_dpp v51, v30, v31 quad_perm:[2,2,2,2] row_mask:0xf bank_mask:0xf
    s_nop 1
    v_add_f32_dpp v50, v50, v51 quad_perm:[1,1,1,1] row_mask:0xf bank_mask:0xf
    s_mov_b64 exec, s[48:49]
    ds_write_b32 v52, v50
    s_mov_b64 exec, -1
    s_waitcnt vmcnt(5)
    buffer_load_dwordx4 v[72:75], v1, s[8:11], s41 offen offset:0 nt
    v_mfma_f32_16x16x32_bf16 v[28:31], v[120:123], v[12:15], 0
    v_mfma_f32_16x16x32_bf16 v[28:31], v[124:127], v[16:19], v[28:31]
    v_mfma_f32_16x16x32_bf16 v[28:31], v[128:131], v[20:23], v[28:31]
    v_mfma_f32_16x16x32_bf16 v[28:31], v[132:135], v[24:27], v[28:31]
    v_add_u32 v52, 64, v52
    s_nop 6
    v_add_f32_dpp v50, v28, v29 quad_perm:[0,0,0,0] row_mask:0xf bank_mask:0xf
    v_add_f32_dpp v51, v30, v31 quad_perm:[2,2,2,2] row_mask:0xf bank_mask:0xf
    s_nop 1
    v_add_f32_dpp v50, v50, v51 quad_perm:[1,1,1,1] row_mask:0xf bank_mask:0xf
    s_mov_b64 exec, s[48:49]
    ds_write_b32 v52, v50
    s_mov_b64 exec, -1
    v_mfma_f32_16x16x32_bf16 v[28:31], v[136:139], v[12:15], 0
    v_mfma_f32_16x16x32_bf16 v[28:31], v[140:143], v[16:19], v[28:31]
    v_mfma_f32_16x16x32_bf16 v[28:31], v[144:147], v[20:23], v[28:31]
    v_mfma_f32_16x16x32_bf16 v[28:31], v[148:151], v[24:27], v[28:31]
    v_add_u32 v52, 64, v52
    s_nop 6
    v_add_f32_dpp v50, v28, v29 quad_perm:[0,0,0,0] row_mask:0xf bank_mask:0xf
    v_add_f32_dpp v51, v30, v31 quad_perm:[2,2,2,2] row_mask:0xf bank_mask:0xf
    s_nop 1
    v_add_f32_dpp v50, v50, v51 quad_perm:[1,1,1,1] row_mask:0xf bank_mask:0xf
    s_mov_b64 exec, s[48:49]
    ds_write_b32 v52, v50
    s_mov_b64 exec, -1
    v_mfma_f32_16x16x32_bf16 v[28:31], v[152:155], v[12:15], 0
    v_mfma_f32_16x16x32_bf16 v[28:31], v[156:159], v[16:19], v[28:31]
    v_mfma_f32_16x16x32_bf16 v[28:31], v[160:163], v[20:23], v[28:31]
    v_mfma_f32_16x16x32_bf16 v[28:31], v[164:167], v[24:27], v[28:31]
    v_add_u32 v52, 64, v52
    s_nop 6
    v_add_f32_dpp v50, v28, v29 quad_perm:[0,0,0,0] row_mask:0xf bank_mask:0xf
    v_add_f32_dpp v51, v30, v31 quad_perm:[2,2,2,2] row_mask:0xf bank_mask:0xf
    s_nop 1
    v_add_f32_dpp v50, v50, v51 quad_perm:[1,1,1,1] row_mask:0xf bank_mask:0xf
    s_mov_b64 exec, s[48:49]
    ds_write_b32 v52, v50
    s_mov_b64 exec, -1
    s_waitcnt vmcnt(5)
    buffer_load_dwordx4 v[76:79], v1, s[8:11], s41 offen offset:1024 nt
    v_mfma_f32_16x16x32_bf16 v[28:31], v[168:171], v[12:15], 0
    v_mfma_f32_16x16x32_bf16 v[28:31], v[172:175], v[16:19], v[28:31]
    v_mfma_f32_16x16x32_bf16 v[28:31], v[176:179], v[20:23], v[28:31]
    v_mfma_f32_16x16x32_bf16 v[28:31], v[180:183], v[24:27], v[28:31]
    v_add_u32 v52, 64, v52
    s_nop 6
    v_add_f32_dpp v50, v28, v29 quad_perm:[0,0,0,0] row_mask:0xf bank_mask:0xf
    v_add_f32_dpp v51, v30, v31 quad_perm:[2,2,2,2] row_mask:0xf bank_mask:0xf
    s_nop 1
    v_add_f32_dpp v50, v50, v51 quad_perm:[1,1,1,1] row_mask:0xf bank_mask:0xf
    s_mov_b64 exec, s[48:49]
    ds_write_b32 v52, v50
    s_mov_b64 exec, -1
    v_mfma_f32_16x16x32_bf16 v[28:31], v[184:187], v[12:15], 0
    v_mfma_f32_16x16x32_bf16 v[28:31], v[188:191], v[16:19], v[28:31]
    v_mfma_f32_16x16x32_bf16 v[28:31], v[192:195], v[20:23], v[28:31]
    v_mfma_f32_16x16x32_bf16 v[28:31], v[196:199], v[24:27], v[28:31]
    v_add_u32 v52, 64, v52
    s_nop 6
    v_add_f32_dpp v50, v28, v29 quad_perm:[0,0,0,0] row_mask:0xf bank_mask:0xf
    v_add_f32_dpp v51, v30, v31 quad_perm:[2,2,2,2] row_mask:0xf bank_mask:0xf
    s_nop 1
    v_add_f32_dpp v50, v50, v51 quad_perm:[1,1,1,1] row_mask:0xf bank_mask:0xf
    s_mov_b64 exec, s[48:49]
    ds_write_b32 v52, v50
    s_mov_b64 exec, -1
    v_mfma_f32_16x16x32_bf16 v[28:31], v[200:203], v[12:15], 0
    v_mfma_f32_16x16x32_bf16 v[28:31], v[204:207], v[16:19], v[28:31]
    v_mfma_f32_16x16x32_bf16 v[28:31], v[208:211], v[20:23], v[28:31]
    v_mfma_f32_16x16x32_bf16 v[28:31], v[212:215], v[24:27], v[28:31]
    v_add_u32 v52, 64, v52
    s_nop 6
    v_add_f32_dpp v50, v28, v29 quad_perm:[0,0,0,0] row_mask:0xf bank_mask:0xf
    v_add_f32_dpp v51, v30, v31 quad_perm:[2,2,2,2] row_mask:0xf bank_mask:0xf
    s_nop 1
    v_add_f32_dpp v50, v50, v51 quad_perm:[1,1,1,1] row_mask:0xf bank_mask:0xf
    s_mov_b64 exec, s[48:49]
    ds_write_b32 v52, v50
    s_mov_b64 exec, -1
    s_waitcnt vmcnt(5)
    buffer_load_dwordx4 v[80:83], v1, s[8:11], s41 offen offset:2048 nt
    v_mfma_f32_16x16x32_bf16 v[28:31], v[216:219], v[12:15], 0
    v_mfma_f32_16x16x32_bf16 v[28:31], v[220:223], v[16:19], v[28:31]
    v_mfma_f32_16x16x32_bf16 v[28:31], v[224:227], v[20:23], v[28:31]
    v_mfma_f32_16x16x32_bf16 v[28:31], v[228:231], v[24:27], v[28:31]
    v_add_u32 v52, 64, v52
    s_nop 6
    v_add_f32_dpp v50, v28, v29 quad_perm:[0,0,0,0] row_mask:0xf bank_mask:0xf
    v_add_f32_dpp v51, v30, v31 quad_perm:[2,2,2,2] row_mask:0xf bank_mask:0xf
    s_nop 1
    v_add_f32_dpp v50, v50, v51 quad_perm:[1,1,1,1] row_mask:0xf bank_mask:0xf
    s_mov_b64 exec, s[48:49]
    ds_write_b32 v52, v50
    s_mov_b64 exec, -1
    v_mfma_f32_16x16x32_bf16 v[28:31], v[232:235], v[12:15], 0
    v_mfma_f32_16x16x32_bf16 v[28:31], v[236:239], v[16:19], v[28:31]
    v_mfma_f32_16x16x32_bf16 v[28:31], v[240:243], v[20:23], v[28:31]
    s_waitcnt vmcnt(5)
    buffer_load_dwordx4 v[84:87], v1, s[8:11], s41 offen offset:3072 nt
    s_xor_b32 s41, s41, s57
    s_add_u32 s41, s41, 0x10000
    s_xor_b32 s41, s41, s57
    v_mfma_f32_16x16x32_bf16 v[28:31], v[244:247], v[24:27], v[28:31]
    v_add_u32 v52, 64, v52
    s_nop 6
    v_add_f32_dpp v50, v28, v29 quad_perm:[0,0,0,0] row_mask:0xf bank_mask:0xf
    v_add_f32_dpp v51, v30, v31 quad_perm:[2,2,2,2] row_mask:0xf bank_mask:0xf
    s_nop 1
    v_add_f32_dpp v50, v50, v51 quad_perm:[1,1,1,1] row_mask:0xf bank_mask:0xf
    s_mov_b64 exec, s[48:49]
    ds_write_b32 v52, v50
    s_mov_b64 exec, -1
    s_mov_b32 s43, 9
L_kloop:
    s_cmp_lg_u32 s51, 0
    s_cbranch_scc1 L_t_1
    s_mov_b64 exec, 1
    ds_add_rtn_u32 v55, v3, v4 offset:352
    s_mov_b64 exec, -1
L_t_1:
    s_bitcmp1_b32 s50, 16
    s_cbranch_scc1 L_d_4
    s_bitcmp1_b32 s50, 8
    s_cbranch_scc1 L_d_3
    s_bitcmp1_b32 s50, 0
    s_cbranch_scc1 L_d_2
    s_waitcnt vmcnt(4)
L_d_2:
    s_waitcnt vmcnt(5)
L_d_3:
    s_waitcnt vmcnt(6)
L_d_4:
    s_waitcnt vmcnt(7)
    v_mfma_f32_16x16x32_bf16 v[28:31], v[56:59], v[12:15], 0
    buffer_load_dwordx4 v[56:59], v1, s[8:11], s41 offen offset:0 nt
    s_cmp_lg_u32 s51, 0
    s_cbranch_scc1 L_t_5
    s_mov_b64 exec, 1
    s_waitcnt lgkmcnt(0)
    v_sub_u32 v55, v55, v54
    v_med3_i32 v55, v55, 0, 3
    v_lshlrev_b32 v55, 2, v55
    ds_read_b32 v55, v55 offset:368
    v_add_u32 v54, 4, v54
    s_mov_b64 exec, -1
L_t_5:
    s_bitcmp1_b32 s50, 17
    s_cbranch_scc1 L_d_8
    s_bitcmp1_b32 s50, 9
    s_cbranch_scc1 L_d_7
    s_bitcmp1_b32 s50, 1
    s_cbranch_scc1 L_d_6
    s_waitcnt vmcnt(4)
L_d_6:
    s_waitcnt vmcnt(5)
L_d_7:
    s_waitcnt vmcnt(6)
L_d_8:
    s_waitcnt vmcnt(7)
    v_mfma_f32_16x16x32_bf16 v[28:31], v[60:63], v[16:19], v[28:31]
    buffer_load_dwordx4 v[60:63], v1, s[8:11], s41 offen offset:1024 nt
    s_cmp_lg_u32 s51, 0
    s_cbranch_scc1 L_t_9
    s_waitcnt lgkmcnt(0)
    v_readfirstlane_b32 s50, v55
L_t_9:
    s_bitcmp1_b32 s50, 18
    s_cbranch_scc1 L_d_12
    s_bitcmp1_b32 s50, 10
    s_cbranch_scc1 L_d_11
    s_bitcmp1_b32 s50, 2
    s_cbranch_scc1 L_d_10
    s_waitcnt vmcnt(4)
L_d_10:
    s_waitcnt vmcnt(5)
L_d_11:
    s_waitcnt vmcnt(6)
L_d_12:
    s_waitcnt vmcnt(7)
    v_mfma_f32_16x16x32_bf16 v[28:31], v[64:67], v[20:23], v[28:31]
    buffer_load_dwordx4 v[64:67], v1, s[8:11], s41 offen offset:2048 nt
    s_bitcmp1_b32 s50, 19
    s_cbranch_scc1 L_d_15
    s_bitcmp1_b32 s50, 11
    s_cbranch_scc1 L_d_14
    s_bitcmp1_b32 s50, 3
    s_cbranch_scc1 L_d_13
    s_waitcnt vmcnt(4)
L_d_13:
    s_waitcnt vmcnt(5)
L_d_14:
    s_waitcnt vmcnt(6)
L_d_15:
    s_waitcnt vmcnt(7)
    v_mfma_f32_16x16x32_bf16 v[28:31], v[68:71], v[24:27], v[28:31]
    buffer_load_dwordx4 v[68:71], v1, s[8:11], s41 offen offset:3072 nt
    s_xor_b32 s41, s41, s57
    s_add_u32 s41, s41, 0x10000
    s_xor_b32 s41, s41, s57
    v_add_u32 v52, 64, v52
    s_nop 2
    v_add_f32_dpp v50, v28, v29 quad_perm:[0,0,0,0] row_mask:0xf bank_mask:0xf
    v_add_f32_dpp v51, v30, v31 quad_perm:[2,2,2,2] row_mask:0xf bank_mask:0xf
    s_nop 1
    v_add_f32_dpp v50, v50, v51 quad_perm:[1,1,1,1] row_mask:0xf bank_mask:0xf
    s_mov_b64 exec, s[48:49]
    ds_write_b32 v52, v50
    s_mov_b64 exec, -1
    s_cmp_lg_u32 s51, 4
    s_cbranch_scc1 L_t_16
    s_mov_b64 exec, 1
    ds_add_rtn_u32 v55, v3, v4 offset:352
    s_mov_b64 exec, -1
L_t_16:
    s_bitcmp1_b32 s50, 20
    s_cbranch_scc1 L_d_19
    s_bitcmp1_b32 s50, 12
    s_cbranch_scc1 L_d_18
    s_bitcmp1_b32 s50, 4
    s_cbranch_scc1 L_d_17
    s_waitcnt vmcnt(4)
L_d_17:
    s_waitcnt vmcnt(5)
L_d_18:
    s_waitcnt vmcnt(6)
L_d_19:
    s_waitcnt vmcnt(7)
    v_mfma_f32_16x16x32_bf16 v[28:31], v[72:75], v[12:15], 0
    buffer_load_dwordx4 v[72:75], v1, s[8:11], s41 offen offset:0 nt
    s_cmp_lg_u32 s51, 4
    s_cbranch_scc1 L_t_20
    s_mov_b64 exec, 1
    s_waitcnt lgkmcnt(0)
    v_sub_u32 v55, v55, v54
    v_med3_i32 v55, v55, 0, 3
    v_lshlrev_b32 v55, 2, v55
    ds_read_b32 v55, v55 offset:368
    v_add_u32 v54, 4, v54
    s_mov_b64 exec, -1
L_t_20:
    s_bitcmp1_b32 s50, 21
    s_cbranch_scc1 L_d_23
    s_bitcmp1_b32 s50, 13
    s_cbranch_scc1 L_d_22
    s_bitcmp1_b32 s50, 5
    s_cbranch_scc1 L_d_21
    s_waitcnt vmcnt(4)
L_d_21:
    s_waitcnt vmcnt(5)
L_d_22:
    s_waitcnt vmcnt(6)
L_d_23:
    s_waitcnt vmcnt(7)
    v_mfma_f32_16x16x32_bf16 v[28:31], v[76:79], v[16:19], v[28:31]
    buffer_load_dwordx4 v[76:79], v1, s[8:11], s41 offen offset:1024 nt
    s_cmp_lg_u32 s51, 4
    s_cbranch_scc1 L_t_24
    s_waitcnt lgkmcnt(0)
    v_readfirstlane_b32 s50, v55
L_t_24:
    s_bitcmp1_b32 s50, 22
    s_cbranch_scc1 L_d_27
    s_bitcmp1_b32 s50, 14
    s_cbranch_scc1 L_d_26
    s_bitcmp1_b32 s50, 6
    s_cbranch_scc1 L_d_25
    s_waitcnt vmcnt(4)
L_d_25:
    s_waitcnt vmcnt(5)
L_d_26:
    s_waitcnt vmcnt(6)
L_d_27:
    s_waitcnt vmcnt(7)
    v_mfma_f32_16x16x32_bf16 v[28:31], v[80:83], v[20:23], v[28:31]
    buffer_load_dwordx4 v[80:83], v1, s[8:11], s41 offen offset:2048 nt
    s_bitcmp1_b32 s50, 23
    s_cbranch_scc1 L_d_30
    s_bitcmp1_b32 s50, 15
    s_cbranch_scc1 L_d_29
    s_bitcmp1_b32 s50, 7
    s_cbranch_scc1 L_d_28
    s_waitcnt vmcnt(4)
L_d_28:
    s_waitcnt vmcnt(5)
L_d_29:
    s_waitcnt vmcnt(6)
L_d_30:
    s_waitcnt vmcnt(7)
    v_mfma_f32_16x16x32_bf16 v[28:31], v[84:87], v[24:27], v[28:31]
    buffer_load_dwordx4 v[84:87], v1, s[8:11], s41 offen offset:3072 nt
    s_xor_b32 s41, s41, s57
    s_add_u32 s41, s41, 0x10000
    s_xor_b32 s41, s41, s57
    v_add_u32 v52, 64, v52
    s_nop 2
    v_add_f32_dpp v50, v28, v29 quad_perm:[0,0,0,0] row_mask:0xf bank_mask:0xf
    v_add_f32_dpp v51, v30, v31 quad_perm:[2,2,2,2] row_mask:0xf bank_mask:0xf
    s_nop 1
    v_add_f32_dpp v50, v50, v51 quad_perm:[1,1,1,1] row_mask:0xf bank_mask:0xf
    s_mov_b64 exec, s[48:49]
    ds_write_b32 v52, v50
    s_mov_b64 exec, -1
    s_sub_u32 s43, s43, 1
    s_cmp_lg_u32 s43, 0
    s_cbranch_scc1 L_kloop
    s_cmp_lg_u32 s51, 0
    s_cbranch_scc1 L_t_31
    s_mov_b64 exec, 1
    ds_add_rtn_u32 v55, v3, v4 offset:352
    s_mov_b64 exec, -1
L_t_31:
    s_bitcmp1_b32 s50, 16
    s_cbranch_scc1 L_d_34
    s_bitcmp1_b32 s50, 8
    s_cbranch_scc1 L_d_33
    s_bitcmp1_b32 s50, 0
    s_cbranch_scc1 L_d_32
    s_waitcnt vmcnt(4)
L_d_32:
    s_waitcnt vmcnt(5)
L_d_33:
    s_waitcnt vmcnt(6)
L_d_34:
    s_waitcnt vmcnt(7)
    buffer_load_dwordx4 v[88:91], v2, s[12:15], s42 offen offset:0 nt
    v_mfma_f32_16x16x32_bf16 v[28:31], v[56:59], v[12:15], 0
    s_cmp_lg_u32 s51, 0
    s_cbranch_scc1 L_t_35
    s_mov_b64 exec, 1
    s_waitcnt lgkmcnt(0)
    v_sub_u32 v55, v55, v54
    v_med3_i32 v55, v55, 0, 3
    v_lshlrev_b32 v55, 2, v55
    ds_read_b32 v55, v55 offset:368
    v_add_u32 v54, 4, v54
    s_mov_b64 exec, -1
L_t_35:
    s_bitcmp1_b32 s50, 17
    s_cbranch_scc1 L_d_38
    s_bitcmp1_b32 s50, 9
    s_cbranch_scc1 L_d_37
    s_bitcmp1_b32 s50, 1
    s_cbranch_scc1 L_d_36
    s_waitcnt vmcnt(4)
L_d_36:
    s_waitcnt vmcnt(5)
L_d_37:
    s_waitcnt vmcnt(6)
L_d_38:
    s_waitcnt vmcnt(7)
    buffer_load_dwordx4 v[92:95], v2, s[12:15], s42 offen offset:1024 nt
    v_mfma_f32_16x16x32_bf16 v[28:31], v[60:63], v[16:19], v[28:31]
    s_cmp_lg_u32 s51, 0
    s_cbranch_scc1 L_t_39
    s_waitcnt lgkmcnt(0)
    v_readfirstlane_b32 s50, v55
L_t_39:
    s_bitcmp1_b32 s50, 18
    s_cbranch_scc1 L_d_42
    s_bitcmp1_b32 s50, 10
    s_cbranch_scc1 L_d_41
    s_bitcmp1_b32 s50, 2
    s_cbranch_scc1 L_d_40
    s_waitcnt vmcnt(4)
L_d_40:
    s_waitcnt vmcnt(5)
L_d_41:
    s_waitcnt vmcnt(6)
L_d_42:
    s_waitcnt vmcnt(7)
    buffer_load_dwordx4 v[96:99], v2, s[12:15], s42 offen offset:2048 nt
    v_mfma_f32_16x16x32_bf16 v[28:31], v[64:67], v[20:23], v[28:31]
    s_bitcmp1_b32 s50, 19
    s_cbranch_scc1 L_d_45
    s_bitcmp1_b32 s50, 11
    s_cbranch_scc1 L_d_44
    s_bitcmp1_b32 s50, 3
    s_cbranch_scc1 L_d_43
    s_waitcnt vmcnt(4)
L_d_43:
    s_waitcnt vmcnt(5)
L_d_44:
    s_waitcnt vmcnt(6)
L_d_45:
    s_waitcnt vmcnt(7)
    buffer_load_dwordx4 v[100:103], v2, s[12:15], s42 offen offset:3072 nt
    s_xor_b32 s42, s42, s57
    s_add_u32 s42, s42, 0x10000
    s_xor_b32 s42, s42, s57
    v_mfma_f32_16x16x32_bf16 v[28:31], v[68:71], v[24:27], v[28:31]
    v_add_u32 v52, 64, v52
    s_nop 6
    v_add_f32_dpp v50, v28, v29 quad_perm:[0,0,0,0] row_mask:0xf bank_mask:0xf
    v_add_f32_dpp v51, v30, v31 quad_perm:[2,2,2,2] row_mask:0xf bank_mask:0xf
    s_nop 1
    v_add_f32_dpp v50, v50, v51 quad_perm:[1,1,1,1] row_mask:0xf bank_mask:0xf
    s_mov_b64 exec, s[48:49]
    ds_write_b32 v52, v50
    s_mov_b64 exec, -1
    s_cmp_lg_u32 s51, 4
    s_cbranch_scc1 L_t_46
    s_mov_b64 exec, 1
    ds_add_rtn_u32 v55, v3, v4 offset:352
    s_mov_b64 exec, -1
L_t_46:
    s_bitcmp1_b32 s50, 20
    s_cbranch_scc1 L_d_49
    s_bitcmp1_b32 s50, 12
    s_cbranch_scc1 L_d_48
    s_bitcmp1_b32 s50, 4
    s_cbranch_scc1 L_d_47
    s_waitcnt vmcnt(4)
L_d_47:
    s_waitcnt vmcnt(5)
L_d_48:
    s_waitcnt vmcnt(6)
L_d_49:
    s_waitcnt vmcnt(7)
    buffer_load_dwordx4 v[104:107], v2, s[12:15], s42 offen offset:0 nt
    v_mfma_f32_16x16x32_bf16 v[28:31], v[72:75], v[12:15], 0
    s_cmp_lg_u32 s51, 4
    s_cbranch_scc1 L_t_50
    s_mov_b64 exec, 1
    s_waitcnt lgkmcnt(0)
    v_sub_u32 v55, v55, v54
    v_med3_i32 v55, v55, 0, 3
    v_lshlrev_b32 v55, 2, v55
    ds_read_b32 v55, v55 offset:368
    v_add_u32 v54, 4, v54
    s_mov_b64 exec, -1
L_t_50:
    s_bitcmp1_b32 s50, 21
    s_cbranch_scc1 L_d_53
    s_bitcmp1_b32 s50, 13
    s_cbranch_scc1 L_d_52
    s_bitcmp1_b32 s50, 5
    s_cbranch_scc1 L_d_51
    s_waitcnt vmcnt(4)
L_d_51:
    s_waitcnt vmcnt(5)
L_d_52:
    s_waitcnt vmcnt(6)
L_d_53:
    s_waitcnt vmcnt(7)
    buffer_load_dwordx4 v[108:111], v2, s[12:15], s42 offen offset:1024 nt
    v_mfma_f32_16x16x32_bf16 v[28:31], v[76:79], v[16:19], v[28:31]
    s_cmp_lg_u32 s51, 4
    s_cbranch_scc1 L_t_54
    s_waitcnt lgkmcnt(0)
    v_readfirstlane_b32 s50, v55
L_t_54:
    s_bitcmp1_b32 s50, 22
    s_cbranch_scc1 L_d_57
    s_bitcmp1_b32 s50, 14
    s_cbranch_scc1 L_d_56
    s_bitcmp1_b32 s50, 6
    s_cbranch_scc1 L_d_55
    s_waitcnt vmcnt(4)
L_d_55:
    s_waitcnt vmcnt(5)
L_d_56:
    s_waitcnt vmcnt(6)
L_d_57:
    s_waitcnt vmcnt(7)
    buffer_load_dwordx4 v[112:115], v2, s[12:15], s42 offen offset:2048 nt
    v_mfma_f32_16x16x32_bf16 v[28:31], v[80:83], v[20:23], v[28:31]
    s_bitcmp1_b32 s50, 23
    s_cbranch_scc1 L_d_60
    s_bitcmp1_b32 s50, 15
    s_cbranch_scc1 L_d_59
    s_bitcmp1_b32 s50, 7
    s_cbranch_scc1 L_d_58
    s_waitcnt vmcnt(4)
L_d_58:
    s_waitcnt vmcnt(5)
L_d_59:
    s_waitcnt vmcnt(6)
L_d_60:
    s_waitcnt vmcnt(7)
    buffer_load_dwordx4 v[116:119], v2, s[12:15], s42 offen offset:3072 nt
    s_xor_b32 s42, s42, s57
    s_add_u32 s42, s42, 0x10000
    s_xor_b32 s42, s42, s57
    v_mfma_f32_16x16x32_bf16 v[28:31], v[84:87], v[24:27], v[28:31]
    v_add_u32 v52, 64, v52
    s_nop 6
    v_add_f32_dpp v50, v28, v29 quad_perm:[0,0,0,0] row_mask:0xf bank_mask:0xf
    v_add_f32_dpp v51, v30, v31 quad_perm:[2,2,2,2] row_mask:0xf bank_mask:0xf
    s_nop 1
    v_add_f32_dpp v50, v50, v51 quad_perm:[1,1,1,1] row_mask:0xf bank_mask:0xf
    s_mov_b64 exec, s[48:49]
    ds_write_b32 v52, v50
    s_mov_b64 exec, -1
    s_waitcnt lgkmcnt(0)
    ds_read_b128 v[12:15], v5
    ds_read_b128 v[16:19], v5 offset:1024
    s_cmp_lg_u32 s51, 0
    s_cbranch_scc1 L_t_61
    s_mov_b64 exec, 1
    ds_add_rtn_u32 v55, v3, v4 offset:352
    s_mov_b64 exec, -1
L_t_61:
    s_bitcmp1_b32 s50, 16
    s_cbranch_scc1 L_d_64
    s_bitcmp1_b32 s50, 8
    s_cbranch_scc1 L_d_63
    s_bitcmp1_b32 s50, 0
    s_cbranch_scc1 L_d_62
    s_waitcnt vmcnt(4)
L_d_62:
    s_waitcnt vmcnt(5)
L_d_63:
    s_waitcnt vmcnt(6)
L_d_64:
    s_waitcnt vmcnt(7)
    buffer_load_dwordx4 v[120:123], v2, s[12:15], s42 offen offset:0 nt
    s_waitcnt lgkmcnt(0)
    v_cvt_pk_bf16_f32 v20, v12, v13
    v_cvt_pk_bf16_f32 v21, v14, v15
    v_cvt_pk_bf16_f32 v22, v16, v17
    v_cvt_pk_bf16_f32 v23, v18, v19
    v_lshlrev_b32 v12, 16, v20
    v_and_b32 v13, s56, v20
    v_lshlrev_b32 v14, 16, v21
    v_and_b32 v15, s56, v21
    v_lshlrev_b32 v16, 16, v22
    v_and_b32 v17, s56, v22
    v_lshlrev_b32 v18, 16, v23
    v_and_b32 v19, s56, v23
    v_pk_mul_f32 v[12:13], v[12:13], s[44:45]
    v_pk_mul_f32 v[14:15], v[14:15], s[44:45]
    v_pk_mul_f32 v[16:17], v[16:17], s[44:45]
    v_pk_mul_f32 v[18:19], v[18:19], s[44:45]
    v_cvt_pk_bf16_f32 v20, v12, v13
    v_cvt_pk_bf16_f32 v21, v14, v15
    v_cvt_pk_bf16_f32 v22, v16, v17
    v_cvt_pk_bf16_f32 v23, v18, v19
    v_lshlrev_b32 v12, 16, v20
    v_and_b32 v13, s56, v20
    v_lshlrev_b32 v14, 16, v21
    v_and_b32 v15, s56, v21
    v_lshlrev_b32 v16, 16, v22
    v_and_b32 v17, s56, v22
    v_lshlrev_b32 v18, 16, v23
    v_and_b32 v19, s56, v23
    v_max3_f32 v48, v12, v13, v14
    v_max3_f32 v50, v15, v16, v17
    v_max3_f32 v48, v48, v18, v19
    v_max_f32 v48, v48, v50
    s_nop 1
    v_max_f32_dpp v48, v48, v48 quad_perm:[1,0,3,2] row_mask:0xf bank_mask:0xf
    s_nop 1
    v_max_f32_dpp v48, v48, v48 quad_perm:[2,3,0,1] row_mask:0xf bank_mask:0xf
    s_nop 1
    v_max_f32_dpp v48, v48, v48 row_half_mirror row_mask:0xf bank_mask:0xf
    s_nop 1
    v_max_f32_dpp v48, v48, v48 row_mirror row_mask:0xf bank_mask:0xf
    v_mov_b32 v51, v48
    s_nop 1
    v_permlane16_swap_b32 v48, v51
    v_max_f32 v48, v48, v51
    v_mov_b32 v51, v48
    s_nop 1
    v_permlane32_swap_b32 v48, v51
    v_max_f32 v48, v48, v51
    s_cmp_lg_u32 s51, 0
    s_cbranch_scc1 L_t_65
    s_mov_b64 exec, 1
    s_waitcnt lgkmcnt(0)
    v_sub_u32 v55, v55, v54
    v_med3_i32 v55, v55, 0, 3
    v_lshlrev_b32 v55, 2, v55
    ds_read_b32 v55, v55 offset:368
    v_add_u32 v54, 4, v54
    s_mov_b64 exec, -1
L_t_65:
    s_bitcmp1_b32 s50, 17
    s_cbranch_scc1 L_d_68
    s_bitcmp1_b32 s50, 9
    s_cbranch_scc1 L_d_67
    s_bitcmp1_b32 s50, 1
    s_cbranch_scc1 L_d_66
    s_waitcnt vmcnt(4)
L_d_66:
    s_waitcnt vmcnt(5)
L_d_67:
    s_waitcnt vmcnt(6)
L_d_68:
    s_waitcnt vmcnt(7)
    buffer_load_dwordx4 v[124:127], v2, s[12:15], s42 offen offset:1024 nt
    v_sub_f32 v12, v12, v48
    v_sub_f32 v13, v13, v48
    v_sub_f32 v14, v14, v48
    v_sub_f32 v15, v15, v48
    v_sub_f32 v16, v16, v48
    v_sub_f32 v17, v17, v48
    v_sub_f32 v18, v18, v48
    v_sub_f32 v19, v19, v48
    v_mul_f32 v12, s46, v12
    v_mul_f32 v13, s46, v13
    v_mul_f32 v14, s46, v14
    v_mul_f32 v15, s46, v15
    v_mul_f32 v16, s46, v16
    v_mul_f32 v17, s46, v17
    v_mul_f32 v18, s46, v18
    v_mul_f32 v19, s46, v19
    v_exp_f32 v12, v12
    v_exp_f32 v13, v13
    v_exp_f32 v14, v14
    v_exp_f32 v15, v15
    v_exp_f32 v16, v16
    v_exp_f32 v17, v17
    v_exp_f32 v18, v18
    v_exp_f32 v19, v19
    v_cvt_pk_bf16_f32 v20, v12, v12
    v_cvt_pk_bf16_f32 v21, v13, v13
    v_cvt_pk_bf16_f32 v22, v14, v14
    v_cvt_pk_bf16_f32 v23, v15, v15
    v_cvt_pk_bf16_f32 v24, v16, v16
    v_cvt_pk_bf16_f32 v25, v17, v17
    v_cvt_pk_bf16_f32 v26, v18, v18
    v_cvt_pk_bf16_f32 v27, v19, v19
    ds_write_b128 v5, v[20:23]
    ds_write_b128 v5, v[24:27] offset:1024
    s_cmp_lg_u32 s51, 0
    s_cbranch_scc1 L_t_69
    s_waitcnt lgkmcnt(0)
    v_readfirstlane_b32 s50, v55
L_t_69:
    s_bitcmp1_b32 s50, 18
    s_cbranch_scc1 L_d_72
    s_bitcmp1_b32 s50, 10
    s_cbranch_scc1 L_d_71
    s_bitcmp1_b32 s50, 2
    s_cbranch_scc1 L_d_70
    s_waitcnt vmcnt(4)
L_d_70:
    s_waitcnt vmcnt(5)
L_d_71:
    s_waitcnt vmcnt(6)
L_d_72:
    s_waitcnt vmcnt(7)
    buffer_load_dwordx4 v[128:131], v2, s[12:15], s42 offen offset:2048 nt
    v_pk_add_f32 v[12:13], v[12:13], v[14:15]
    v_pk_add_f32 v[16:17], v[16:17], v[18:19]
    v_pk_add_f32 v[12:13], v[12:13], v[16:17]
    v_add_f32 v49, v12, v13
    ds_read_b128 v[44:47], v53
    v_add_u32 v53, 64, v53
    v_add_f32_dpp v49, v49, v49 quad_perm:[1,0,3,2] row_mask:0xf bank_mask:0xf
    s_nop 1
    v_add_f32_dpp v49, v49, v49 quad_perm:[2,3,0,1] row_mask:0xf bank_mask:0xf
    s_nop 1
    v_add_f32_dpp v49, v49, v49 row_half_mirror row_mask:0xf bank_mask:0xf
    s_nop 1
    v_add_f32_dpp v49, v49, v49 row_mirror row_mask:0xf bank_mask:0xf
    v_mov_b32 v51, v49
    s_nop 1
    v_permlane16_swap_b32 v49, v51
    v_add_f32 v49, v49, v51
    v_mov_b32 v51, v49
    s_nop 1
    v_permlane32_swap_b32 v49, v51
    v_add_f32 v49, v49, v51
    s_mov_b64 exec, 1
    ds_write_b64 v7, v[48:49]
    s_mov_b64 exec, -1
    s_waitcnt lgkmcnt(0)
    v_and_b32 v36, v44, v8
    v_and_b32 v37, v44, v9
    v_and_b32 v38, v44, v10
    v_and_b32 v39, v44, v11
    s_nop 1
    v_mfma_f32_16x16x32_bf16 v[32:35], v[88:91], v[36:39], v[32:35]
    v_and_b32 v40, v45, v8
    v_and_b32 v41, v45, v9
    v_and_b32 v42, v45, v10
    v_and_b32 v43, v45, v11
    s_nop 1
    v_mfma_f32_16x16x32_bf16 v[32:35], v[92:95], v[40:43], v[32:35]
    v_and_b32 v36, v46, v8
    v_and_b32 v37, v46, v9
    v_and_b32 v38, v46, v10
    v_and_b32 v39, v46, v11
    s_bitcmp1_b32 s50, 19
    s_cbranch_scc1 L_d_75
    s_bitcmp1_b32 s50, 11
    s_cbranch_scc1 L_d_74
    s_bitcmp1_b32 s50, 3
    s_cbranch_scc1 L_d_73
    s_waitcnt vmcnt(4)
L_d_73:
    s_waitcnt vmcnt(5)
L_d_74:
    s_waitcnt vmcnt(6)
L_d_75:
    s_waitcnt vmcnt(7)
    buffer_load_dwordx4 v[132:135], v2, s[12:15], s42 offen offset:3072 nt
    s_xor_b32 s42, s42, s57
    s_add_u32 s42, s42, 0x10000
    s_xor_b32 s42, s42, s57
    v_mfma_f32_16x16x32_bf16 v[32:35], v[96:99], v[36:39], v[32:35]
    v_and_b32 v40, v47, v8
    v_and_b32 v41, v47, v9
    v_and_b32 v42, v47, v10
    v_and_b32 v43, v47, v11
    ds_read_b128 v[44:47], v53
    v_add_u32 v53, 64, v53
    v_mfma_f32_16x16x32_bf16 v[32:35], v[100:103], v[40:43], v[32:35]
    s_waitcnt lgkmcnt(0)
    v_and_b32 v36, v44, v8
    v_and_b32 v37, v44, v9
    v_and_b32 v38, v44, v10
    v_and_b32 v39, v44, v11
    s_cmp_lg_u32 s51, 4
    s_cbranch_scc1 L_t_76
    s_mov_b64 exec, 1
    ds_add_rtn_u32 v55, v3, v4 offset:352
    s_mov_b64 exec, -1
L_t_76:
    s_bitcmp1_b32 s50, 20
    s_cbranch_scc1 L_d_79
    s_bitcmp1_b32 s50, 12
    s_cbranch_scc1 L_d_78
    s_bitcmp1_b32 s50, 4
    s_cbranch_scc1 L_d_77
    s_waitcnt vmcnt(4)
L_d_77:
    s_waitcnt vmcnt(5)
L_d_78:
    s_waitcnt vmcnt(6)
L_d_79:
    s_waitcnt vmcnt(7)
    buffer_load_dwordx4 v[136:139], v2, s[12:15], s42 offen offset:0 nt
    v_mfma_f32_16x16x32_bf16 v[32:35], v[104:107], v[36:39], v[32:35]
    v_and_b32 v40, v45, v8
    v_and_b32 v41, v45, v9
    v_and_b32 v42, v45, v10
    v_and_b32 v43, v45, v11
    s_cmp_lg_u32 s51, 4
    s_cbranch_scc1 L_t_80
    s_mov_b64 exec, 1
    s_waitcnt lgkmcnt(0)
    v_sub_u32 v55, v55, v54
    v_med3_i32 v55, v55, 0, 3
    v_lshlrev_b32 v55, 2, v55
    ds_read_b32 v55, v55 offset:368
    v_add_u32 v54, 4, v54
    s_mov_b64 exec, -1
L_t_80:
    s_bitcmp1_b32 s50, 21
    s_cbranch_scc1 L_d_83
    s_bitcmp1_b32 s50, 13
    s_cbranch_scc1 L_d_82
    s_bitcmp1_b32 s50, 5
    s_cbranch_scc1 L_d_81
    s_waitcnt vmcnt(4)
L_d_81:
    s_waitcnt vmcnt(5)
L_d_82:
    s_waitcnt vmcnt(6)
L_d_83:
    s_waitcnt vmcnt(7)
    buffer_load_dwordx4 v[140:143], v2, s[12:15], s42 offen offset:1024 nt
    v_mfma_f32_16x16x32_bf16 v[32:35], v[108:111], v[40:43], v[32:35]
    v_and_b32 v36, v46, v8
    v_and_b32 v37, v46, v9
    v_and_b32 v38, v46, v10
    v_and_b32 v39, v46, v11
    s_cmp_lg_u32 s51, 4
    s_cbranch_scc1 L_t_84
    s_waitcnt lgkmcnt(0)
    v_readfirstlane_b32 s50, v55
L_t_84:
    s_bitcmp1_b32 s50, 22
    s_cbranch_scc1 L_d_87
    s_bitcmp1_b32 s50, 14
    s_cbranch_scc1 L_d_86
    s_bitcmp1_b32 s50, 6
    s_cbranch_scc1 L_d_85
    s_waitcnt vmcnt(4)
L_d_85:
    s_waitcnt vmcnt(5)
L_d_86:
    s_waitcnt vmcnt(6)
L_d_87:
    s_waitcnt vmcnt(7)
    buffer_load_dwordx4 v[144:147], v2, s[12:15], s42 offen offset:2048 nt
    v_mfma_f32_16x16x32_bf16 v[32:35], v[112:115], v[36:39], v[32:35]
    v_and_b32 v40, v47, v8
    v_and_b32 v41, v47, v9
    v_and_b32 v42, v47, v10
    v_and_b32 v43, v47, v11
    ds_read_b128 v[44:47], v53
    v_add_u32 v53, 64, v53
    s_bitcmp1_b32 s50, 23
    s_cbranch_scc1 L_d_90
    s_bitcmp1_b32 s50, 15
    s_cbranch_scc1 L_d_89
    s_bitcmp1_b32 s50, 7
    s_cbranch_scc1 L_d_88
    s_waitcnt vmcnt(4)
L_d_88:
    s_waitcnt vmcnt(5)
L_d_89:
    s_waitcnt vmcnt(6)
L_d_90:
    s_waitcnt vmcnt(7)
    buffer_load_dwordx4 v[148:151], v2, s[12:15], s42 offen offset:3072 nt
    s_xor_b32 s42, s42, s57
    s_add_u32 s42, s42, 0x10000
    s_xor_b32 s42, s42, s57
    v_mfma_f32_16x16x32_bf16 v[32:35], v[116:119], v[40:43], v[32:35]
    s_waitcnt lgkmcnt(0)
    v_and_b32 v36, v44, v8
    v_and_b32 v37, v44, v9
    v_and_b32 v38, v44, v10
    v_and_b32 v39, v44, v11
    s_cmp_lg_u32 s51, 0
    s_cbranch_scc1 L_t_91
    s_mov_b64 exec, 1
    ds_add_rtn_u32 v55, v3, v4 offset:352
    s_mov_b64 exec, -1
L_t_91:
    s_bitcmp1_b32 s50, 16
    s_cbranch_scc1 L_d_94
    s_bitcmp1_b32 s50, 8
    s_cbranch_scc1 L_d_93
    s_bitcmp1_b32 s50, 0
    s_cbranch_scc1 L_d_92
    s_waitcnt vmcnt(4)
L_d_92:
    s_waitcnt vmcnt(5)
L_d_93:
    s_waitcnt vmcnt(6)
L_d_94:
    s_waitcnt vmcnt(7)
    buffer_load_dwordx4 v[56:59], v2, s[12:15], s42 offen offset:0 nt
    v_mfma_f32_16x16x32_bf16 v[32:35], v[120:123], v[36:39], v[32:35]
    v_and_b32 v40, v45, v8
    v_and_b32 v41, v45, v9
    v_and_b32 v42, v45, v10
    v_and_b32 v43, v45, v11
    s_cmp_lg_u32 s51, 0
    s_cbranch_scc1 L_t_95
    s_mov_b64 exec, 1
    s_waitcnt lgkmcnt(0)
    v_sub_u32 v55, v55, v54
    v_med3_i32 v55, v55, 0, 3
    v_lshlrev_b32 v55, 2, v55
    ds_read_b32 v55, v55 offset:368
    v_add_u32 v54, 4, v54
    s_mov_b64 exec, -1
L_t_95:
    s_bitcmp1_b32 s50, 17
    s_cbranch_scc1 L_d_98
    s_bitcmp1_b32 s50, 9
    s_cbranch_scc1 L_d_97
    s_bitcmp1_b32 s50, 1
    s_cbranch_scc1 L_d_96
    s_waitcnt vmcnt(4)
L_d_96:
    s_waitcnt vmcnt(5)
L_d_97:
    s_waitcnt vmcnt(6)
L_d_98:
    s_waitcnt vmcnt(7)
    buffer_load_dwordx4 v[60:63], v2, s[12:15], s42 offen offset:1024 nt
    v_mfma_f32_16x16x32_bf16 v[32:35], v[124:127], v[40:43], v[32:35]
    v_and_b32 v36, v46, v8
    v_and_b32 v37, v46, v9
    v_and_b32 v38, v46, v10
    v_and_b32 v39, v46, v11
    s_cmp_lg_u32 s51, 0
    s_cbranch_scc1 L_t_99
    s_waitcnt lgkmcnt(0)
    v_readfirstlane_b32 s50, v55
L_t_99:
    s_bitcmp1_b32 s50, 18
    s_cbranch_scc1 L_d_102
    s_bitcmp1_b32 s50, 10
    s_cbranch_scc1 L_d_101
    s_bitcmp1_b32 s50, 2
    s_cbranch_scc1 L_d_100
    s_waitcnt vmcnt(4)
L_d_100:
    s_waitcnt vmcnt(5)
L_d_101:
    s_waitcnt vmcnt(6)
L_d_102:
    s_waitcnt vmcnt(7)
    buffer_load_dwordx4 v[64:67], v2, s[12:15], s42 offen offset:2048 nt
    v_mfma_f32_16x16x32_bf16 v[32:35], v[128:131], v[36:39], v[32:35]
    v_and_b32 v40, v47, v8
    v_and_b32 v41, v47, v9
    v_and_b32 v42, v47, v10
    v_and_b32 v43, v47, v11
    ds_read_b128 v[44:47], v53
    v_add_u32 v53, 64, v53
    s_bitcmp1_b32 s50, 19
    s_cbranch_scc1 L_d_105
    s_bitcmp1_b32 s50, 11
    s_cbranch_scc1 L_d_104
    s_bitcmp1_b32 s50, 3
    s_cbranch_scc1 L_d_103
    s_waitcnt vmcnt(4)
L_d_103:
    s_waitcnt vmcnt(5)
L_d_104:
    s_waitcnt vmcnt(6)
L_d_105:
    s_waitcnt vmcnt(7)
    buffer_load_dwordx4 v[68:71], v2, s[12:15], s42 offen offset:3072 nt
    s_xor_b32 s42, s42, s57
    s_add_u32 s42, s42, 0x10000
    s_xor_b32 s42, s42, s57
    v_mfma_f32_16x16x32_bf16 v[32:35], v[132:135], v[40:43], v[32:35]
    s_waitcnt lgkmcnt(0)
    v_and_b32 v36, v44, v8
    v_and_b32 v37, v44, v9
    v_and_b32 v38, v44, v10
    v_and_b32 v39, v44, v11
    s_cmp_lg_u32 s51, 4
    s_cbranch_scc1 L_t_106
    s_mov_b64 exec, 1
    ds_add_rtn_u32 v55, v3, v4 offset:352
    s_mov_b64 exec, -1
L_t_106:
    s_bitcmp1_b32 s50, 20
    s_cbranch_scc1 L_d_109
    s_bitcmp1_b32 s50, 12
    s_cbranch_scc1 L_d_108
    s_bitcmp1_b32 s50, 4
    s_cbranch_scc1 L_d_107
    s_waitcnt vmcnt(4)
L_d_107:
    s_waitcnt vmcnt(5)
L_d_108:
    s_waitcnt vmcnt(6)
L_d_109:
    s_waitcnt vmcnt(7)
    buffer_load_dwordx4 v[72:75], v2, s[12:15], s42 offen offset:0 nt
    v_mfma_f32_16x16x32_bf16 v[32:35], v[136:139], v[36:39], v[32:35]
    v_and_b32 v40, v45, v8
    v_and_b32 v41, v45, v9
    v_and_b32 v42, v45, v10
    v_and_b32 v43, v45, v11
    s_cmp_lg_u32 s51, 4
    s_cbranch_scc1 L_t_110
    s_mov_b64 exec, 1
    s_waitcnt lgkmcnt(0)
    v_sub_u32 v55, v55, v54
    v_med3_i32 v55, v55, 0, 3
    v_lshlrev_b32 v55, 2, v55
    ds_read_b32 v55, v55 offset:368
    v_add_u32 v54, 4, v54
    s_mov_b64 exec, -1
L_t_110:
    s_bitcmp1_b32 s50, 21
    s_cbranch_scc1 L_d_113
    s_bitcmp1_b32 s50, 13
    s_cbranch_scc1 L_d_112
    s_bitcmp1_b32 s50, 5
    s_cbranch_scc1 L_d_111
    s_waitcnt vmcnt(4)
L_d_111:
    s_waitcnt vmcnt(5)
L_d_112:
    s_waitcnt vmcnt(6)
L_d_113:
    s_waitcnt vmcnt(7)
    buffer_load_dwordx4 v[76:79], v2, s[12:15], s42 offen offset:1024 nt
    v_mfma_f32_16x16x32_bf16 v[32:35], v[140:143], v[40:43], v[32:35]
    v_and_b32 v36, v46, v8
    v_and_b32 v37, v46, v9
    v_and_b32 v38, v46, v10
    v_and_b32 v39, v46, v11
    s_cmp_lg_u32 s51, 4
    s_cbranch_scc1 L_t_114
    s_waitcnt lgkmcnt(0)
    v_readfirstlane_b32 s50, v55
L_t_114:
    s_bitcmp1_b32 s50, 22
    s_cbranch_scc1 L_d_117
    s_bitcmp1_b32 s50, 14
    s_cbranch_scc1 L_d_116
    s_bitcmp1_b32 s50, 6
    s_cbranch_scc1 L_d_115
    s_waitcnt vmcnt(4)
L_d_115:
    s_waitcnt vmcnt(5)
L_d_116:
    s_waitcnt vmcnt(6)
L_d_117:
    s_waitcnt vmcnt(7)
    buffer_load_dwordx4 v[80:83], v2, s[12:15], s42 offen offset:2048 nt
    v_mfma_f32_16x16x32_bf16 v[32:35], v[144:147], v[36:39], v[32:35]
    v_and_b32 v40, v47, v8
    v_and_b32 v41, v47, v9
    v_and_b32 v42, v47, v10
    v_and_b32 v43, v47, v11
    ds_read_b128 v[44:47], v53
    v_add_u32 v53, 64, v53
    s_bitcmp1_b32 s50, 23
    s_cbranch_scc1 L_d_120
    s_bitcmp1_b32 s50, 15
    s_cbranch_scc1 L_d_119
    s_bitcmp1_b32 s50, 7
    s_cbranch_scc1 L_d_118
    s_waitcnt vmcnt(4)
L_d_118:
    s_waitcnt vmcnt(5)
L_d_119:
    s_waitcnt vmcnt(6)
L_d_120:
    s_waitcnt vmcnt(7)
    buffer_load_dwordx4 v[84:87], v2, s[12:15], s42 offen offset:3072 nt
    s_xor_b32 s42, s42, s57
    s_add_u32 s42, s42, 0x10000
    s_xor_b32 s42, s42, s57
    v_mfma_f32_16x16x32_bf16 v[32:35], v[148:151], v[40:43], v[32:35]
    s_waitcnt lgkmcnt(0)
    v_and_b32 v36, v44, v8
    v_and_b32 v37, v44, v9
    v_and_b32 v38, v44, v10
    v_and_b32 v39, v44, v11
    s_mov_b32 s43, 13
L_vloop:
    s_cmp_lg_u32 s51, 0
    s_cbranch_scc1 L_t_121
    s_mov_b64 exec, 1
    ds_add_rtn_u32 v55, v3, v4 offset:352
    s_mov_b64 exec, -1
L_t_121:
    s_bitcmp1_b32 s50, 16
    s_cbranch_scc1 L_d_124
    s_bitcmp1_b32 s50, 8
    s_cbranch_scc1 L_d_123
    s_bitcmp1_b32 s50, 0
    s_cbranch_scc1 L_d_122
    s_waitcnt vmcnt(4)
L_d_122:
    s_waitcnt vmcnt(5)
L_d_123:
    s_waitcnt vmcnt(6)
L_d_124:
    s_waitcnt vmcnt(7)
    v_mfma_f32_16x16x32_bf16 v[32:35], v[56:59], v[36:39], v[32:35]
    buffer_load_dwordx4 v[56:59], v2, s[12:15], s42 offen offset:0 nt
    v_and_b32 v40, v45, v8
    v_and_b32 v41, v45, v9
    v_and_b32 v42, v45, v10
    v_and_b32 v43, v45, v11
    s_cmp_lg_u32 s51, 0
    s_cbranch_scc1 L_t_125
    s_mov_b64 exec, 1
    s_waitcnt lgkmcnt(0)
    v_sub_u32 v55, v55, v54
    v_med3_i32 v55, v55, 0, 3
    v_lshlrev_b32 v55, 2, v55
    ds_read_b32 v55, v55 offset:368
    v_add_u32 v54, 4, v54
    s_mov_b64 exec, -1
L_t_125:
    s_bitcmp1_b32 s50, 17
    s_cbranch_scc1 L_d_128
    s_bitcmp1_b32 s50, 9
    s_cbranch_scc1 L_d_127
    s_bitcmp1_b32 s50, 1
    s_cbranch_scc1 L_d_126
    s_waitcnt vmcnt(4)
L_d_126:
    s_waitcnt vmcnt(5)
L_d_127:
    s_waitcnt vmcnt(6)
L_d_128:
    s_waitcnt vmcnt(7)
    v_mfma_f32_16x16x32_bf16 v[32:35], v[60:63], v[40:43], v[32:35]
    buffer_load_dwordx4 v[60:63], v2, s[12:15], s42 offen offset:1024 nt
    v_and_b32 v36, v46, v8
    v_and_b32 v37, v46, v9
    v_and_b32 v38, v46, v10
    v_and_b32 v39, v46, v11
    s_cmp_lg_u32 s51, 0
    s_cbranch_scc1 L_t_129
    s_waitcnt lgkmcnt(0)
    v_readfirstlane_b32 s50, v55
L_t_129:
    s_bitcmp1_b32 s50, 18
    s_cbranch_scc1 L_d_132
    s_bitcmp1_b32 s50, 10
    s_cbranch_scc1 L_d_131
    s_bitcmp1_b32 s50, 2
    s_cbranch_scc1 L_d_130
    s_waitcnt vmcnt(4)
L_d_130:
    s_waitcnt vmcnt(5)
L_d_131:
    s_waitcnt vmcnt(6)
L_d_132:
    s_waitcnt vmcnt(7)
    v_mfma_f32_16x16x32_bf16 v[32:35], v[64:67], v[36:39], v[32:35]
    buffer_load_dwordx4 v[64:67], v2, s[12:15], s42 offen offset:2048 nt
    v_and_b32 v40, v47, v8
    v_and_b32 v41, v47, v9
    v_and_b32 v42, v47, v10
    v_and_b32 v43, v47, v11
    ds_read_b128 v[44:47], v53
    v_add_u32 v53, 64, v53
    s_bitcmp1_b32 s50, 19
    s_cbranch_scc1 L_d_135
    s_bitcmp1_b32 s50, 11
    s_cbranch_scc1 L_d_134
    s_bitcmp1_b32 s50, 3
    s_cbranch_scc1 L_d_133
    s_waitcnt vmcnt(4)
L_d_133:
    s_waitcnt vmcnt(5)
L_d_134:
    s_waitcnt vmcnt(6)
L_d_135:
    s_waitcnt vmcnt(7)
    v_mfma_f32_16x16x32_bf16 v[32:35], v[68:71], v[40:43], v[32:35]
    buffer_load_dwordx4 v[68:71], v2, s[12:15], s42 offen offset:3072 nt
    s_xor_b32 s42, s42, s57
    s_add_u32 s42, s42, 0x10000
    s_xor_b32 s42, s42, s57
    s_waitcnt lgkmcnt(0)
    v_and_b32 v36, v44, v8
    v_and_b32 v37, v44, v9
    v_and_b32 v38, v44, v10
    v_and_b32 v39, v44, v11
    s_cmp_lg_u32 s51, 4
    s_cbranch_scc1 L_t_136
    s_mov_b64 exec, 1
    ds_add_rtn_u32 v55, v3, v4 offset:352
    s_mov_b64 exec, -1
L_t_136:
    s_bitcmp1_b32 s50, 20
    s_cbranch_scc1 L_d_139
    s_bitcmp1_b32 s50, 12
    s_cbranch_scc1 L_d_138
    s_bitcmp1_b32 s50, 4
    s_cbranch_scc1 L_d_137
    s_waitcnt vmcnt(4)
L_d_137:
    s_waitcnt vmcnt(5)
L_d_138:
    s_waitcnt vmcnt(6)
L_d_139:
    s_waitcnt vmcnt(7)
    v_mfma_f32_16x16x32_bf16 v[32:35], v[72:75], v[36:39], v[32:35]
    buffer_load_dwordx4 v[72:75], v2, s[12:15], s42 offen offset:0 nt
    v_and_b32 v40, v45, v8
    v_and_b32 v41, v45, v9
    v_and_b32 v42, v45, v10
    v_and_b32 v43, v45, v11
    s_cmp_lg_u32 s51, 4
    s_cbranch_scc1 L_t_140
    s_mov_b64 exec, 1
    s_waitcnt lgkmcnt(0)
    v_sub_u32 v55, v55, v54
    v_med3_i32 v55, v55, 0, 3
    v_lshlrev_b32 v55, 2, v55
    ds_read_b32 v55, v55 offset:368
    v_add_u32 v54, 4, v54
    s_mov_b64 exec, -1
L_t_140:
    s_bitcmp1_b32 s50, 21
    s_cbranch_scc1 L_d_143
    s_bitcmp1_b32 s50, 13
    s_cbranch_scc1 L_d_142
    s_bitcmp1_b32 s50, 5
    s_cbranch_scc1 L_d_141
    s_waitcnt vmcnt(4)
L_d_141:
    s_waitcnt vmcnt(5)
L_d_142:
    s_waitcnt vmcnt(6)
L_d_143:
    s_waitcnt vmcnt(7)
    v_mfma_f32_16x16x32_bf16 v[32:35], v[76:79], v[40:43], v[32:35]
    buffer_load_dwordx4 v[76:79], v2, s[12:15], s42 offen offset:1024 nt
    v_and_b32 v36, v46, v8
    v_and_b32 v37, v46, v9
    v_and_b32 v38, v46, v10
    v_and_b32 v39, v46, v11
    s_cmp_lg_u32 s51, 4
    s_cbranch_scc1 L_t_144
    s_waitcnt lgkmcnt(0)
    v_readfirstlane_b32 s50, v55
L_t_144:
    s_bitcmp1_b32 s50, 22
    s_cbranch_scc1 L_d_147
    s_bitcmp1_b32 s50, 14
    s_cbranch_scc1 L_d_146
    s_bitcmp1_b32 s50, 6
    s_cbranch_scc1 L_d_145
    s_waitcnt vmcnt(4)
L_d_145:
    s_waitcnt vmcnt(5)
L_d_146:
    s_waitcnt vmcnt(6)
L_d_147:
    s_waitcnt vmcnt(7)
    v_mfma_f32_16x16x32_bf16 v[32:35], v[80:83], v[36:39], v[32:35]
    buffer_load_dwordx4 v[80:83], v2, s[12:15], s42 offen offset:2048 nt
    v_and_b32 v40, v47, v8
    v_and_b32 v41, v47, v9
    v_and_b32 v42, v47, v10
    v_and_b32 v43, v47, v11
    ds_read_b128 v[44:47], v53
    v_add_u32 v53, 64, v53
    s_bitcmp1_b32 s50, 23
    s_cbranch_scc1 L_d_150
    s_bitcmp1_b32 s50, 15
    s_cbranch_scc1 L_d_149
    s_bitcmp1_b32 s50, 7
    s_cbranch_scc1 L_d_148
    s_waitcnt vmcnt(4)
L_d_148:
    s_waitcnt vmcnt(5)
L_d_149:
    s_waitcnt vmcnt(6)
L_d_150:
    s_waitcnt vmcnt(7)
    v_mfma_f32_16x16x32_bf16 v[32:35], v[84:87], v[40:43], v[32:35]
    buffer_load_dwordx4 v[84:87], v2, s[12:15], s42 offen offset:3072 nt
    s_xor_b32 s42, s42, s57
    s_add_u32 s42, s42, 0x10000
    s_xor_b32 s42, s42, s57
    s_waitcnt lgkmcnt(0)
    v_and_b32 v36, v44, v8
    v_and_b32 v37, v44, v9
    v_and_b32 v38, v44, v10
    v_and_b32 v39, v44, v11
    s_sub_u32 s43, s43, 1
    s_cmp_lg_u32 s43, 0
    s_cbranch_scc1 L_vloop
    s_branch L_pg_151
.p2align 12,,640
L_pg_151:
    s_barrier
    s_waitcnt vmcnt(7)
    v_mfma_f32_16x16x32_bf16 v[32:35], v[56:59], v[36:39], v[32:35]
    v_and_b32 v40, v45, v8
    v_and_b32 v41, v45, v9
    v_and_b32 v42, v45, v10
    v_and_b32 v43, v45, v11
    s_waitcnt vmcnt(6)
    s_nop 0
    v_mfma_f32_16x16x32_bf16 v[32:35], v[60:63], v[40:43], v[32:35]
    v_and_b32 v36, v46, v8
    v_and_b32 v37, v46, v9
    v_and_b32 v38, v46, v10
    v_and_b32 v39, v46, v11
    s_waitcnt vmcnt(5)
    s_nop 0
    v_mfma_f32_16x16x32_bf16 v[32:35], v[64:67], v[36:39], v[32:35]
    v_and_b32 v40, v47, v8
    v_and_b32 v41, v47, v9
    v_and_b32 v42, v47, v10
    v_and_b32 v43, v47, v11
    ds_read_b128 v[44:47], v53
    v_add_u32 v53, 64, v53
    s_waitcnt vmcnt(4)
    v_mfma_f32_16x16x32_bf16 v[32:35], v[68:71], v[40:43], v[32:35]
    s_waitcnt lgkmcnt(0)
    v_and_b32 v36, v44, v8
    v_and_b32 v37, v44, v9
    v_and_b32 v38, v44, v10
    v_and_b32 v39, v44, v11
    v_and_b32 v16, v45, v8
    v_and_b32 v17, v45, v9
    v_and_b32 v18, v45, v10
    v_and_b32 v19, v45, v11
    v_and_b32 v20, v46, v8
    v_and_b32 v21, v46, v9
    v_and_b32 v22, v46, v10
    v_and_b32 v23, v46, v11
    v_and_b32 v24, v47, v8
    v_and_b32 v25, v47, v9
    v_and_b32 v26, v47, v10
    v_and_b32 v27, v47, v11
    s_nop 0
    s_waitcnt vmcnt(3)
    v_mfma_f32_16x16x32_bf16 v[32:35], v[72:75], v[36:39], v[32:35]
    s_waitcnt vmcnt(2)
    v_mfma_f32_16x16x32_bf16 v[32:35], v[76:79], v[16:19], v[32:35]
    s_waitcnt vmcnt(1)
    v_mfma_f32_16x16x32_bf16 v[32:35], v[80:83], v[20:23], v[32:35]
    s_waitcnt vmcnt(0)
    v_mfma_f32_16x16x32_bf16 v[32:35], v[84:87], v[24:27], v[32:35]
    s_mov_b32 exec_lo, 0x00ff00ff
    s_mov_b32 exec_hi, 0x00ff00ff
    s_nop 5
    ds_write_b128 v6, v[32:35]
    s_waitcnt lgkmcnt(0)
    s_barrier
    s_mov_b64 exec, -1
    s_cmp_lt_u32 s3, 2
    s_cbranch_scc0 L_send
    s_cmp_ge_u32 s2, 160
    s_cbranch_scc0 L_red
    s_and_b32 s11, s2, 7
    s_mul_i32 s10, s11, 12
    s_sub_u32 s12, s2, 160
    s_lshr_b32 s12, s12, 3
    s_add_u32 s10, s10, s12
    s_sub_u32 s10, s10, 40
    s_cmp_lt_u32 s10, 54
    s_cbranch_scc0 L_send
    s_barrier
    s_mov_b32 s56, 0xffff0000
    s_mov_b32 s57, 0x3fb8aa3b
    s_mov_b32 s58, 0x3f803f80
    s_mov_b32 s59, 0x3acccccd
    s_mov_b32 s40, s38
    s_and_b32 s41, s39, 0xffff
    s_mov_b32 s42, 2097152
    s_mov_b32 s43, 0x20000
    s_lshl_b32 s11, s11, 13
    s_mul_i32 s10, s3, 1280
    s_add_u32 s10, s10, s11
    s_add_u32 s10, s10, 1773568
    v_lshlrev_b32 v6, 2, v0
    s_lshl_b32 s12, s3, 3
    s_add_u32 s12, s12, 320
    v_mov_b32 v7, s12
    s_mov_b32 s52, 0
    s_mov_b32 s53, 0x80000000
    s_branch L_pg_152
.p2align 12,,704
L_pg_152:
    s_barrier
    s_mov_b32 s60, 200000
    buffer_load_dwordx4 v[24:27], v2, s[40:43], s10 offen sc1
    buffer_load_dword v28, v6, s[40:43], s10 offen offset:1024 sc1
    s_sleep 2
L_poll_153:
    buffer_load_dwordx4 v[32:35], v2, s[40:43], s10 offen sc1
    buffer_load_dword v36, v6, s[40:43], s10 offen offset:1024 sc1
    s_sub_u32 s60, s60, 1
    s_cbranch_scc1 L_end
    s_waitcnt vmcnt(2)
    v_dot2_f32_bf16 v14, v24, s58, 0
    v_dot2_f32_bf16 v15, v24, v24, 0
    v_dot2_f32_bf16 v14, v25, s58, v14
    v_dot2_f32_bf16 v15, v25, v25, v15
    v_dot2_f32_bf16 v14, v26, s58, v14
    v_dot2_f32_bf16 v15, v26, v26, v15
    v_dot2_f32_bf16 v14, v27, s58, v14
    v_dot2_f32_bf16 v15, v27, v27, v15
    v_dot2_f32_bf16 v14, v28, s58, v14
    v_dot2_f32_bf16 v15, v28, v28, v15
    v_max3_u32 v16, v24, v25, v26
    v_max3_u32 v16, v16, v27, v28
    v_cmp_eq_u32 vcc, -1, v16
    s_cbranch_vccz L_gotA_154
    buffer_load_dwordx4 v[24:27], v2, s[40:43], s10 offen sc1
    buffer_load_dword v28, v6, s[40:43], s10 offen offset:1024 sc1
    s_waitcnt vmcnt(2)
    v_dot2_f32_bf16 v14, v32, s58, 0
    v_dot2_f32_bf16 v15, v32, v32, 0
    v_dot2_f32_bf16 v14, v33, s58, v14
    v_dot2_f32_bf16 v15, v33, v33, v15
    v_dot2_f32_bf16 v14, v34, s58, v14
    v_dot2_f32_bf16 v15, v34, v34, v15
    v_dot2_f32_bf16 v14, v35, s58, v14
    v_dot2_f32_bf16 v15, v35, v35, v15
    v_dot2_f32_bf16 v14, v36, s58, v14
    v_dot2_f32_bf16 v15, v36, v36, v15
    v_max3_u32 v16, v32, v33, v34
    v_max3_u32 v16, v16, v35, v36
    v_cmp_eq_u32 vcc, -1, v16
    s_cbranch_vccnz L_poll_153
L_gotA_154:
    v_add_f32_dpp v14, v14, v14 quad_perm:[1,0,3,2] row_mask:0xf bank_mask:0xf
    v_add_f32_dpp v15, v15, v15 quad_perm:[1,0,3,2] row_mask:0xf bank_mask:0xf
    s_nop 0
    v_add_f32_dpp v14, v14, v14 quad_perm:[2,3,0,1] row_mask:0xf bank_mask:0xf
    v_add_f32_dpp v15, v15, v15 quad_perm:[2,3,0,1] row_mask:0xf bank_mask:0xf
    s_nop 0
    v_add_f32_dpp v14, v14, v14 row_half_mirror row_mask:0xf bank_mask:0xf
    v_add_f32_dpp v15, v15, v15 row_half_mirror row_mask:0xf bank_mask:0xf
    s_nop 0
    v_add_f32_dpp v14, v14, v14 row_mirror row_mask:0xf bank_mask:0xf
    v_add_f32_dpp v15, v15, v15 row_mirror row_mask:0xf bank_mask:0xf
    s_nop 0
    v_add_f32_dpp v14, v14, v14 row_bcast:15 row_mask:0xa bank_mask:0xf
    v_add_f32_dpp v15, v15, v15 row_bcast:15 row_mask:0xa bank_mask:0xf
    s_nop 0
    v_add_f32_dpp v14, v14, v14 row_bcast:31 row_mask:0xc bank_mask:0xf
    v_add_f32_dpp v15, v15, v15 row_bcast:31 row_mask:0xc bank_mask:0xf
    v_mul_f32 v14, s59, v14
    v_mul_f32 v15, s59, v15
    v_fma_f32 v15, -v14, v14, v15
    v_max_f32 v15, 0, v15
    v_add_f32 v15, 0x3727c5ac, v15
    v_rsq_f32 v15, v15
    s_mov_b64 exec, s[52:53]
    ds_write_b64 v7, v[14:15]
    s_waitcnt lgkmcnt(0)
    s_barrier
    s_endpgm
L_red:
    s_lshr_b32 s54, s2, 3
    s_and_b32 s53, s2, 7
    s_cmp_ge_u32 s53, 3
    s_cbranch_scc1 L_red1
    s_mul_i32 s55, s53, 6
    s_sub_u32 s55, s54, s55
    s_cmp_lt_u32 s55, 6
    s_cbranch_scc0 L_send
L_red1:
    s_barrier
    s_mov_b32 s40, s38
    s_and_b32 s41, s39, 0xffff
    s_mov_b32 s42, 2097152
    s_mov_b32 s43, 0x20000
    v_and_b32 v6, 3, v0
    v_bfe_u32 v7, v0, 4, 1
    v_lshl_add_u32 v6, v7, 2, v6
    v_bfe_u32 v7, v0, 2, 2
    v_lshrrev_b32 v8, 5, v0
    v_lshl_add_u32 v13, v6, 1, v8
    s_mul_i32 s11, s3, 1280
    s_lshl_b32 s12, s54, 6
    s_add_u32 s11, s11, s12
    s_lshl_b32 s12, s3, 7
    v_lshl_add_u32 v12, v13, 3, s12
    ds_read_b64 v[14:15], v12 offset:3584
    s_add_u32 s11, s11, 4096
    v_lshl_add_u32 v10, v13, 2, s11
    s_mul_i32 s11, s54, 205
    s_lshr_b32 s11, s11, 10
    s_mul_i32 s12, s11, 5
    s_sub_u32 s12, s54, s12
    s_lshl_b32 s11, s11, 10
    s_lshl_b32 s13, s3, 4
    s_add_u32 s11, s11, s13
    s_cmp_eq_u32 s12, 4
    s_cbranch_scc1 L_rdense
    s_and_b32 s13, s12, 1
    s_lshl_b32 s13, s13, 9
    s_add_u32 s11, s11, s13
    s_lshr_b32 s13, s12, 1
    s_lshl_b32 s13, s13, 6
    s_add_u32 s11, s11, s13
    s_add_u32 s11, s11, 64
    v_bfe_u32 v9, v13, 1, 2
    v_lshlrev_b32 v9, 2, v9
    v_and_b32 v11, 1, v13
    v_lshl_add_u32 v9, v11, 5, v9
    v_lshrrev_b32 v11, 3, v13
    s_branch L_raddr
L_rdense:
    v_and_b32 v9, 3, v13
    v_lshlrev_b32 v9, 2, v9
    v_lshrrev_b32 v11, 2, v13
L_raddr:
    v_lshl_add_u32 v9, v11, 8, v9
    v_add_u32 v9, s11, v9
    v_cmp_eq_u32 vcc, 0, v7
    s_nop 1
    v_cndmask_b32 v13, v10, v9, vcc
    v_lshl_add_u32 v12, v8, 2, v7
    v_lshlrev_b32 v12, 7, v12
    v_lshl_add_u32 v12, v6, 4, v12
    v_mov_b32 v16, 0
    ds_read_b32 v16, v16 offset:384
    s_waitcnt lgkmcnt(0)
    v_readfirstlane_b32 s27, v16
    s_and_b32 s52, s27, 2
    s_lshl_b32 s52, s52, 12
    s_lshl_b32 s55, s54, 2
    s_add_u32 s55, s55, s3
    s_lshl_b32 s55, s55, 12
    s_add_u32 s52, s52, s55
    s_add_u32 s52, s52, 1376256
    s_lshl_b32 s53, s53, 13
    s_add_u32 s53, s53, 1769472
    s_branch L_pg_156
.p2align 12,,768
L_pg_156:
    s_mov_b32 s50, 0x00ff00ff
    s_mov_b32 s51, 0x00ff00ff
    s_barrier
    s_mov_b32 s60, 200000
    buffer_load_dwordx4 v[32:35], v12, s[40:43], s52 offen offset:0 sc1
    buffer_load_dwordx4 v[36:39], v12, s[40:43], s52 offen offset:1024 sc1
    buffer_load_dwordx4 v[40:43], v12, s[40:43], s52 offen offset:2048 sc1
    buffer_load_dwordx4 v[44:47], v12, s[40:43], s52 offen offset:3072 sc1
    s_sleep 2
L_poll_157:
    buffer_load_dwordx4 v[56:59], v12, s[40:43], s52 offen offset:0 sc1
    buffer_load_dwordx4 v[60:63], v12, s[40:43], s52 offen offset:1024 sc1
    buffer_load_dwordx4 v[64:67], v12, s[40:43], s52 offen offset:2048 sc1
    buffer_load_dwordx4 v[68:71], v12, s[40:43], s52 offen offset:3072 sc1
    s_sub_u32 s60, s60, 1
    s_cbranch_scc1 L_end
    s_waitcnt vmcnt(4)
    v_pk_add_f32 v[20:21], v[32:33], v[36:37]
    v_pk_add_f32 v[24:25], v[40:41], v[44:45]
    v_pk_add_f32 v[22:23], v[34:35], v[38:39]
    v_pk_add_f32 v[26:27], v[42:43], v[46:47]
    v_pk_add_f32 v[20:21], v[20:21], v[24:25]
    v_pk_add_f32 v[22:23], v[22:23], v[26:27]
    v_max_u32 v16, v32, v33
    v_max3_u32 v16, v16, v34, v35
    v_permlane32_swap_b32 v20, v22
    v_permlane32_swap_b32 v21, v23
    v_pk_add_f32 v[20:21], v[20:21], v[22:23]
    v_max3_u32 v16, v16, v36, v37
    v_max3_u32 v16, v16, v38, v39
    v_add_f32_dpp v20, v20, v20 row_ror:8 row_mask:0xf bank_mask:0xf
    v_add_f32_dpp v21, v21, v21 row_ror:8 row_mask:0xf bank_mask:0xf
    v_max3_u32 v16, v16, v40, v41
    v_add_f32_dpp v20, v20, v20 row_ror:4 row_mask:0xf bank_mask:0xf
    v_add_f32_dpp v21, v21, v21 row_ror:4 row_mask:0xf bank_mask:0xf
    v_max3_u32 v16, v16, v42, v43
    v_max3_u32 v16, v16, v44, v45
    v_max3_u32 v16, v16, v46, v47
    v_cmp_eq_u32 vcc, -1, v16
    s_cbranch_vccz L_gotA_158
    buffer_load_dwordx4 v[32:35], v12, s[40:43], s52 offen offset:0 sc1
    buffer_load_dwordx4 v[36:39], v12, s[40:43], s52 offen offset:1024 sc1
    buffer_load_dwordx4 v[40:43], v12, s[40:43], s52 offen offset:2048 sc1
    buffer_load_dwordx4 v[44:47], v12, s[40:43], s52 offen offset:3072 sc1
    s_waitcnt vmcnt(4)
    v_pk_add_f32 v[20:21], v[56:57], v[60:61]
    v_pk_add_f32 v[24:25], v[64:65], v[68:69]
    v_pk_add_f32 v[22:23], v[58:59], v[62:63]
    v_pk_add_f32 v[26:27], v[66:67], v[70:71]
    v_pk_add_f32 v[20:21], v[20:21], v[24:25]
    v_pk_add_f32 v[22:23], v[22:23], v[26:27]
    v_max_u32 v16, v56, v57
    v_max3_u32 v16, v16, v58, v59
    v_permlane32_swap_b32 v20, v22
    v_permlane32_swap_b32 v21, v23
    v_pk_add_f32 v[20:21], v[20:21], v[22:23]
    v_max3_u32 v16, v16, v60, v61
    v_max3_u32 v16, v16, v62, v63
    v_add_f32_dpp v20, v20, v20 row_ror:8 row_mask:0xf bank_mask:0xf
    v_add_f32_dpp v21, v21, v21 row_ror:8 row_mask:0xf bank_mask:0xf
    v_max3_u32 v16, v16, v64, v65
    v_add_f32_dpp v20, v20, v20 row_ror:4 row_mask:0xf bank_mask:0xf
    v_add_f32_dpp v21, v21, v21 row_ror:4 row_mask:0xf bank_mask:0xf
    v_max3_u32 v16, v16, v66, v67
    v_max3_u32 v16, v16, v68, v69
    v_max3_u32 v16, v16, v70, v71
    v_cmp_eq_u32 vcc, -1, v16
    s_cbranch_vccnz L_poll_157
L_gotA_158:
    v_pk_add_f32 v[14:15], v[14:15], v[20:21]
    s_mov_b64 exec, s[50:51]
    s_bitcmp1_b32 s27, 0
    v_cvt_pk_bf16_f32 v16, v14, v15
    s_cbranch_scc0 L_hslow
    buffer_store_dword v16, v13, s[40:43], s53 offen
L_hdone:
L_send:
    s_endpgm
L_hset:
    buffer_load_dword v12, v56, s[40:43], 0 offen sc1
    s_mov_b32 s56, 0xffff0000
    s_mov_b32 s57, 0x3fb8aa3b
    s_mov_b32 s58, 0x3f803f80
    s_mov_b32 s59, 0x3acccccd
    s_mov_b32 s61, 0x05040100
    s_mov_b32 s62, 0x07060302
    s_mov_b32 s63, 0
    s_sub_u32 s10, s2, 160
    s_and_b32 s11, s10, 7
    s_mul_i32 s11, s11, 12
    s_lshr_b32 s10, s10, 3
    s_add_u32 s10, s10, s11
    s_sub_u32 s11, s10, 40
    s_cmp_lt_u32 s10, 94
    s_cselect_b32 s8, 2, 3
    s_cmp_lt_u32 s10, 40
    s_cselect_b32 s8, 1, s8
    s_cselect_b32 s9, s10, s11
    s_cmp_lt_u32 s5, 5
    s_cselect_b32 s8, 0, s8
    s_cselect_b32 s9, s5, s9
    s_lshl_b32 s10, s4, 3
    s_lshl_b32 s11, s6, 2
    s_add_u32 s11, s11, s7
    s_add_u32 s11, s10, s11
    s_lshl_b32 s10, s4, 11
    s_add_u32 s10, s10, 1835008
    s_lshl_b32 s12, s7, 6
    s_add_u32 s10, s10, s12
    s_lshl_b32 s12, s6, 5
    s_add_u32 s10, s10, s12
    v_lshrrev_b32 v1, 3, v0
    v_lshlrev_b32 v1, 8, v1
    v_and_b32 v2, 7, v0
    v_lshl_add_u32 v1, v2, 2, v1
    v_add_u32 v1, s10, v1
    s_and_b32 s10, s11, 7
    s_lshl_b32 s10, s10, 3
    s_lshl_b32 s11, s4, 7
    s_add_u32 s10, s10, s11
    s_add_u32 s10, s10, 1900544
    v_mov_b32 v2, s10
    s_cmp_eq_u32 s3, 0
    s_cbranch_scc1 L_qpath
    s_cmp_eq_u32 s3, 1
    s_cbranch_scc0 L_b0
L_noblk:
    s_sub_u32 s10, 255, s2
    s_cmp_lt_u32 s10, 48
    s_cbranch_scc0 L_wsel
    s_lshl_b32 s10, s10, 12
    s_add_u32 s10, s10, 1048576
    s_mov_b64 exec, 1
    buffer_store_dword v56, v56, s[40:43], s10 offen sc1
    s_mov_b64 exec, -1
L_wsel:
    s_lshr_b32 s10, s2, 3
    s_lshl_b32 s10, s10, 12
    s_and_b32 s11, s2, 7
    s_lshl_b32 s11, s11, 2
    s_add_u32 s10, s10, s11
    s_add_u32 s10, s10, 1048704
    v_mov_b32 v6, s10
    s_getreg_b32 s10, hwreg(HW_REG_XCC_ID, 0, 4)
    s_waitcnt vmcnt(0)
    v_add_u32 v7, 0x9e3779b9, v12
    v_xor_b32 v7, s10, v7
    s_mov_b64 exec, 1
    buffer_store_dword v7, v6, s[40:43], 0 offen sc1
    s_mov_b64 exec, -1
    s_branch L_b0
L_qpath:
    s_lshl_b32 s10, s4, 13
    s_add_u32 s10, s10, 65536
    v_mov_b32 v14, 0
    v_mov_b32 v15, 0
    s_waitcnt vmcnt(21)
    v_dot2c_f32_bf16 v14, s58, v24
    v_dot2c_f32_bf16 v15, v24, v24
    v_dot2c_f32_bf16 v14, s58, v25
    v_dot2c_f32_bf16 v15, v25, v25
    v_dot2c_f32_bf16 v14, s58, v26
    v_dot2c_f32_bf16 v15, v26, v26
    v_dot2c_f32_bf16 v14, s58, v27
    v_dot2c_f32_bf16 v15, v27, v27
    v_dot2c_f32_bf16 v14, s58, v28
    v_dot2c_f32_bf16 v15, v28, v28
    v_dot2c_f32_bf16 v14, s58, v29
    v_dot2c_f32_bf16 v15, v29, v29
    v_dot2c_f32_bf16 v14, s58, v30
    v_dot2c_f32_bf16 v15, v30, v30
    v_dot2c_f32_bf16 v14, s58, v31
    v_dot2c_f32_bf16 v15, v31, v31
    v_dot2c_f32_bf16 v14, s58, v32
    v_dot2c_f32_bf16 v15, v32, v32
    v_dot2c_f32_bf16 v14, s58, v33
    v_dot2c_f32_bf16 v15, v33, v33
    v_and_b32 v9, 1, v6
    v_lshlrev_b32 v9, 4, v9
    v_mov_b32 v10, 0xffff
    v_lshlrev_b32 v10, v9, v10
    v_lshrrev_b32 v9, 1, v6
    v_add_f32_dpp v14, v14, v14 quad_perm:[1,0,3,2] row_mask:0xf bank_mask:0xf
    v_add_f32_dpp v15, v15, v15 quad_perm:[1,0,3,2] row_mask:0xf bank_mask:0xf
    s_nop 0
    v_add_f32_dpp v14, v14, v14 quad_perm:[2,3,0,1] row_mask:0xf bank_mask:0xf
    v_add_f32_dpp v15, v15, v15 quad_perm:[2,3,0,1] row_mask:0xf bank_mask:0xf
    s_nop 0
    v_add_f32_dpp v14, v14, v14 row_half_mirror row_mask:0xf bank_mask:0xf
    v_add_f32_dpp v15, v15, v15 row_half_mirror row_mask:0xf bank_mask:0xf
    v_mov_b32 v16, v14
    v_mov_b32 v17, v15
    s_nop 0
    v_permlane16_swap_b32 v14, v16
    v_permlane16_swap_b32 v15, v17
    v_add_f32 v14, v14, v16
    v_add_f32 v15, v15, v17
    v_mov_b32 v16, v14
    v_mov_b32 v17, v15
    s_nop 0
    v_permlane32_swap_b32 v14, v16
    v_permlane32_swap_b32 v15, v17
    v_add_f32 v14, v14, v16
    v_add_f32 v15, v15, v17
    v_mul_f32 v14, s59, v14
    v_mul_f32 v15, s59, v15
    v_fma_f32 v15, -v14, v14, v15
    v_max_f32 v15, 0, v15
    v_cvt_pk_bf16_f32 v16, v14, v15
    v_lshlrev_b32 v14, 16, v16
    v_and_b32 v15, s56, v16
    v_add_f32 v15, 0x3727c5ac, v15
    v_cvt_pk_bf16_f32 v15, v15, v15
    v_and_b32 v15, s56, v15
    v_sqrt_f32 v15, v15
    s_nop 0
    v_cvt_pk_bf16_f32 v15, v15, v15
    v_and_b32 v15, s56, v15
    v_rcp_f32 v15, v15
    v_lshlrev_b32 v16, 16, v34
    v_and_b32 v17, s56, v34
    v_sub_f32 v16, v16, v14
    v_sub_f32 v17, v17, v14
    v_cvt_pk_bf16_f32 v17, v16, v17
    v_lshlrev_b32 v16, 16, v17
    v_and_b32 v17, s56, v17
    v_mul_f32 v16, v15, v16
    v_mul_f32 v17, v15, v17
    v_cvt_pk_bf16_f32 v16, v16, v16
    v_cvt_pk_bf16_f32 v17, v17, v17
    v_lshlrev_b32 v18, 16, v35
    v_and_b32 v19, s56, v35
    v_sub_f32 v18, v18, v14
    v_sub_f32 v19, v19, v14
    v_cvt_pk_bf16_f32 v19, v18, v19
    v_lshlrev_b32 v18, 16, v19
    v_and_b32 v19, s56, v19
    v_mul_f32 v18, v15, v18
    v_mul_f32 v19, v15, v19
    v_cvt_pk_bf16_f32 v18, v18, v18
    v_cvt_pk_bf16_f32 v19, v19, v19
    v_lshlrev_b32 v13, 4, v0
    ds_write_b128 v13, v[16:19] offset:2560
    v_and_b32 v13, 0x380, v13
    ds_read_b128 v[24:27], v13 offset:2560
    ds_read_b128 v[28:31], v13 offset:2576
    ds_read_b128 v[32:35], v13 offset:2592
    ds_read_b128 v[36:39], v13 offset:2608
    ds_read_b128 v[40:43], v13 offset:2624
    v_cmp_eq_u32 vcc, 0, v9
    s_nop 1
    v_cndmask_b32 v44, 0, v10, vcc
    v_cmp_eq_u32 vcc, 1, v9
    s_nop 1
    v_cndmask_b32 v45, 0, v10, vcc
    v_cmp_eq_u32 vcc, 2, v9
    s_nop 1
    v_cndmask_b32 v46, 0, v10, vcc
    v_cmp_eq_u32 vcc, 3, v9
    s_nop 1
    v_cndmask_b32 v47, 0, v10, vcc
    s_waitcnt lgkmcnt(0)
    v_and_b32 v16, v24, v44
    v_and_b32 v17, v24, v45
    v_and_b32 v18, v24, v46
    v_and_b32 v19, v24, v47
    v_and_b32 v20, v25, v44
    v_and_b32 v21, v25, v45
    v_and_b32 v22, v25, v46
    v_and_b32 v23, v25, v47
    s_waitcnt vmcnt(17)
    v_mfma_f32_16x16x32_bf16 v[60:63], v[96:99], v[16:19], 0
    v_and_b32 v16, v26, v44
    v_and_b32 v17, v26, v45
    v_and_b32 v18, v26, v46
    v_and_b32 v19, v26, v47
    v_mfma_f32_16x16x32_bf16 v[60:63], v[100:103], v[20:23], v[60:63]
    v_and_b32 v20, v27, v44
    v_and_b32 v21, v27, v45
    v_and_b32 v22, v27, v46
    v_and_b32 v23, v27, v47
    v_mfma_f32_16x16x32_bf16 v[60:63], v[104:107], v[16:19], v[60:63]
    v_and_b32 v16, v28, v44
    v_and_b32 v17, v28, v45
    v_and_b32 v18, v28, v46
    v_and_b32 v19, v28, v47
    v_mfma_f32_16x16x32_bf16 v[60:63], v[108:111], v[20:23], v[60:63]
    v_and_b32 v20, v29, v44
    v_and_b32 v21, v29, v45
    v_and_b32 v22, v29, v46
    v_and_b32 v23, v29, v47
    s_waitcnt vmcnt(13)
    v_mfma_f32_16x16x32_bf16 v[60:63], v[112:115], v[16:19], v[60:63]
    v_and_b32 v16, v30, v44
    v_and_b32 v17, v30, v45
    v_and_b32 v18, v30, v46
    v_and_b32 v19, v30, v47
    v_mfma_f32_16x16x32_bf16 v[60:63], v[116:119], v[20:23], v[60:63]
    v_and_b32 v20, v31, v44
    v_and_b32 v21, v31, v45
    v_and_b32 v22, v31, v46
    v_and_b32 v23, v31, v47
    v_mfma_f32_16x16x32_bf16 v[60:63], v[120:123], v[16:19], v[60:63]
    v_and_b32 v16, v32, v44
    v_and_b32 v17, v32, v45
    v_and_b32 v18, v32, v46
    v_and_b32 v19, v32, v47
    v_mfma_f32_16x16x32_bf16 v[60:63], v[124:127], v[20:23], v[60:63]
    v_and_b32 v20, v33, v44
    v_and_b32 v21, v33, v45
    v_and_b32 v22, v33, v46
    v_and_b32 v23, v33, v47
    s_waitcnt vmcnt(9)
    v_mfma_f32_16x16x32_bf16 v[60:63], v[128:131], v[16:19], v[60:63]
    v_and_b32 v16, v34, v44
    v_and_b32 v17, v34, v45
    v_and_b32 v18, v34, v46
    v_and_b32 v19, v34, v47
    v_mfma_f32_16x16x32_bf16 v[60:63], v[132:135], v[20:23], v[60:63]
    v_and_b32 v20, v35, v44
    v_and_b32 v21, v35, v45
    v_and_b32 v22, v35, v46
    v_and_b32 v23, v35, v47
    v_mfma_f32_16x16x32_bf16 v[60:63], v[136:139], v[16:19], v[60:63]
    v_and_b32 v16, v36, v44
    v_and_b32 v17, v36, v45
    v_and_b32 v18, v36, v46
    v_and_b32 v19, v36, v47
    v_mfma_f32_16x16x32_bf16 v[60:63], v[140:143], v[20:23], v[60:63]
    v_and_b32 v20, v37, v44
    v_and_b32 v21, v37, v45
    v_and_b32 v22, v37, v46
    v_and_b32 v23, v37, v47
    s_waitcnt vmcnt(5)
    v_mfma_f32_16x16x32_bf16 v[60:63], v[144:147], v[16:19], v[60:63]
    v_and_b32 v16, v38, v44
    v_and_b32 v17, v38, v45
    v_and_b32 v18, v38, v46
    v_and_b32 v19, v38, v47
    v_mfma_f32_16x16x32_bf16 v[60:63], v[148:151], v[20:23], v[60:63]
    v_and_b32 v20, v39, v44
    v_and_b32 v21, v39, v45
    v_and_b32 v22, v39, v46
    v_and_b32 v23, v39, v47
    v_mfma_f32_16x16x32_bf16 v[60:63], v[152:155], v[16:19], v[60:63]
    v_and_b32 v16, v40, v44
    v_and_b32 v17, v40, v45
    v_and_b32 v18, v40, v46
    v_and_b32 v19, v40, v47
    v_mfma_f32_16x16x32_bf16 v[60:63], v[156:159], v[20:23], v[60:63]
    v_and_b32 v20, v41, v44
    v_and_b32 v21, v41, v45
    v_and_b32 v22, v41, v46
    v_and_b32 v23, v41, v47
    s_waitcnt vmcnt(1)
    v_mfma_f32_16x16x32_bf16 v[60:63], v[160:163], v[16:19], v[60:63]
    v_and_b32 v16, v42, v44
    v_and_b32 v17, v42, v45
    v_and_b32 v18, v42, v46
    v_and_b32 v19, v42, v47
    v_mfma_f32_16x16x32_bf16 v[60:63], v[164:167], v[20:23], v[60:63]
    v_and_b32 v20, v43, v44
    v_and_b32 v21, v43, v45
    v_and_b32 v22, v43, v46
    v_and_b32 v23, v43, v47
    v_mfma_f32_16x16x32_bf16 v[60:63], v[168:171], v[16:19], v[60:63]
    s_nop 0
    v_mfma_f32_16x16x32_bf16 v[60:63], v[172:175], v[20:23], v[60:63]
    s_waitcnt vmcnt(0)
    v_readfirstlane_b32 s63, v12
    s_lshl_b32 s11, s5, 9
    s_add_u32 s11, s11, s10
    s_add_u32 s63, s63, 0x9e3779b9
    v_lshlrev_b32 v56, 12, v5
    v_lshl_add_u32 v56, v8, 4, v56
    v_add_u32 v56, s11, v56
    v_and_b32 v52, 1, v0
    v_lshlrev_b32 v52, 4, v52
    v_lshrrev_b32 v52, v52, s63
    v_bfe_u32 v55, v52, 12, 4
    v_bfe_u32 v54, v52, 8, 4
    v_bfe_u32 v53, v52, 4, 4
    v_bfe_u32 v52, v52, 0, 4
    v_and_or_b32 v48, v60, -16, v52
    v_and_or_b32 v49, v61, -16, v53
    v_and_or_b32 v50, v62, -16, v54
    v_and_or_b32 v51, v63, -16, v55
    buffer_store_dwordx4 v[48:51], v56, s[40:43], 0 offen
L_qget:
    s_lshl_b32 s11, s6, 12
    s_add_u32 s10, s10, s11
    v_lshlrev_b32 v9, 4, v0
    s_mov_b32 s60, 200000
L_qpoll:
    buffer_load_dwordx4 v[64:67], v9, s[40:43], s10 offen offset:0 sc1
    buffer_load_dwordx4 v[68:71], v9, s[40:43], s10 offen offset:1024 sc1
    buffer_load_dwordx4 v[72:75], v9, s[40:43], s10 offen offset:2048 sc1
    buffer_load_dwordx4 v[76:79], v9, s[40:43], s10 offen offset:3072 sc1
    s_waitcnt vmcnt(0)
    v_xor_b32 v64, v64, v52
    v_xor_b32 v65, v65, v53
    v_xor_b32 v66, v66, v54
    v_xor_b32 v67, v67, v55
    v_xor_b32 v68, v68, v52
    v_xor_b32 v69, v69, v53
    v_xor_b32 v70, v70, v54
    v_xor_b32 v71, v71, v55
    v_xor_b32 v72, v72, v52
    v_xor_b32 v73, v73, v53
    v_xor_b32 v74, v74, v54
    v_xor_b32 v75, v75, v55
    v_xor_b32 v76, v76, v52
    v_xor_b32 v77, v77, v53
    v_xor_b32 v78, v78, v54
    v_xor_b32 v79, v79, v55
    v_or_b32 v14, v64, v65
    v_or3_b32 v14, v14, v66, v67
    v_or3_b32 v14, v14, v68, v69
    v_or3_b32 v14, v14, v70, v71
    v_or3_b32 v14, v14, v72, v73
    v_or3_b32 v14, v14, v74, v75
    v_or3_b32 v14, v14, v76, v77
    v_or3_b32 v14, v14, v78, v79
    v_and_b32 v14, 15, v14
    v_cmp_ne_u32 vcc, 0, v14
    s_cbranch_vccz L_qgot
    s_cmp_eq_u32 s60, 199988
    s_cbranch_scc0 L_qnext
    buffer_store_dwordx4 v[48:51], v56, s[40:43], 0 offen sc1
L_qnext:
    s_sub_u32 s60, s60, 1
    s_cbranch_scc0 L_qpoll
L_qgot:
    v_pk_add_f32 v[64:65], v[64:65], v[68:69]
    v_pk_add_f32 v[66:67], v[66:67], v[70:71]
    v_pk_add_f32 v[64:65], v[64:65], v[72:73]
    v_pk_add_f32 v[66:67], v[66:67], v[74:75]
    v_pk_add_f32 v[64:65], v[64:65], v[76:77]
    v_pk_add_f32 v[66:67], v[66:67], v[78:79]
    s_nop 1
    v_permlane32_swap_b32 v64, v66
    v_permlane32_swap_b32 v65, v67
    v_pk_add_f32 v[64:65], v[64:65], v[66:67]
    v_cvt_pk_bf16_f32 v14, v64, v65
    v_bfe_u32 v9, v0, 3, 2
    v_lshlrev_b32 v9, 6, v9
    v_and_b32 v10, 32, v0
    v_add_u32 v9, v9, v10
    v_and_b32 v10, 7, v0
    v_lshl_add_u32 v9, v10, 1, v9
    v_lshlrev_b32 v10, 2, v10
    v_mov_b32 v15, -1
    ds_write_b32 v10, v15 offset:256
    v_bfe_u32 v15, v0, 2, 1
    v_mul_u32_u24 v15, 255, v15
    ds_write_b32 v10, v15 offset:352
    ds_write_b16 v9, v14 offset:0
    ds_write_b16_d16_hi v9, v14 offset:16
    s_waitcnt lgkmcnt(0)
    s_setprio 0
L_b0:
    s_barrier
    s_waitcnt vmcnt(0)
    v_readfirstlane_b32 s63, v12
    s_add_u32 s63, s63, 0x9e3779b9
    s_cmp_eq_u32 s8, 0
    s_cbranch_scc1 L_roleW
    s_cmp_eq_u32 s8, 1
    s_cbranch_scc1 L_roleD
    s_cmp_eq_u32 s8, 2
    s_cbranch_scc1 L_roleG
    s_cmp_eq_u32 s2, 255
    s_cbranch_scc0 L_noprobe
    s_cmp_eq_u32 s3, 1
    s_cbranch_scc0 L_noprobe
    v_lshlrev_b32 v16, 12, v3
    v_mov_b32 v17, 1
    buffer_store_dword v17, v16, s[40:43], 0 offen offset:2048 sc1
    s_waitcnt vmcnt(0)
    s_mov_b32 s16, 0
    s_mov_b32 s17, 0
L_probe:
    s_and_b32 s18, s16, 15
    s_lshl_b32 s18, s18, 12
    s_add_u32 s18, s18, 2048
    s_mov_b32 s19, 0
    s_mov_b32 s20, -4000
    s_load_dword s19, s[38:39], s18 glc
L_probe1:
    s_add_u32 s20, s20, 1
    s_cbranch_scc1 L_probe2
    s_cmp_eq_u32 s19, 0
    s_cbranch_scc1 L_probe1
L_probe2:
    s_waitcnt lgkmcnt(0)
    s_bitcmp1_b32 s16, 1
    s_cselect_b32 s21, -1, 1
    s_mul_i32 s20, s20, s21
    s_add_u32 s17, s17, s20
    s_add_u32 s16, s16, 1
    s_cmp_lt_u32 s16, 32
    s_cbranch_scc1 L_probe
    s_cmp_gt_i32 s17, 0
    s_cselect_b32 s18, 1, 0
    s_getreg_b32 s19, hwreg(HW_REG_XCC_ID, 2, 1)
    s_xor_b32 s18, s18, s19
    s_xor_b32 s18, s18, s63
    v_mov_b32 v16, 1343744
    v_mov_b32 v17, s18
    s_mov_b64 exec, 1
    buffer_store_dword v17, v16, s[40:43], 0 offen sc1
    s_mov_b64 exec, -1
L_noprobe:
    s_cmp_ge_u32 s3, 2
    s_cbranch_scc0 L_noctl_166
    s_lshr_b32 s18, s2, 3
    s_mul_i32 s19, s18, 205
    s_lshr_b32 s19, s19, 10
    s_mov_b32 s23, 1000
    s_lshl_b32 s17, s19, 12
    s_add_u32 s20, s38, 1048576
    s_addc_u32 s21, s39, 0
    s_and_b32 s24, s2, 7
    s_cmp_ge_u32 s24, 3
    s_cselect_b32 s27, 0, 0
    s_and_b32 s24, s2, 7
    s_lshl_b32 s24, s24, 12
    s_add_u32 s24, s24, 1312768
    s_lshl_b32 s18, s18, 2
    s_lshl_b32 s19, s19, 2
    s_add_u32 s19, s19, 128
    v_mov_b32 v21, s18
    v_mov_b32 v22, s19
    v_mov_b32 v16, 0
    v_lshlrev_b32 v17, 3, v0
    v_lshlrev_b32 v23, 2, v0
    s_sub_u32 s16, s3, 1
    v_mov_b32 v25, 0x7fffffff
    v_writelane_b32 v25, 60, 0
    s_mov_b32 s19, 72
    v_writelane_b32 v25, s19, 1
    s_mov_b32 s19, 66
    v_writelane_b32 v25, s19, 2
    s_mov_b32 s19, 78
    v_writelane_b32 v25, s19, 3
    v_writelane_b32 v25, 63, 4
    s_mov_b32 s19, 75
    v_writelane_b32 v25, s19, 5
    s_mov_b32 s19, 69
    v_writelane_b32 v25, s19, 6
    s_mov_b32 s19, 81
    v_writelane_b32 v25, s19, 7
    s_mov_b32 s19, 83
    v_writelane_b32 v25, s19, 8
    s_mov_b32 s19, 91
    v_writelane_b32 v25, s19, 9
    s_mov_b32 s19, 87
    v_writelane_b32 v25, s19, 10
    s_mov_b32 s19, 95
    v_writelane_b32 v25, s19, 11
    s_mov_b32 s19, 85
    v_writelane_b32 v25, s19, 12
    s_mov_b32 s19, 93
    v_writelane_b32 v25, s19, 13
    s_mov_b32 s19, 89
    v_writelane_b32 v25, s19, 14
    s_mov_b32 s19, 97
    v_writelane_b32 v25, s19, 15
    s_mov_b32 s19, 99
    v_writelane_b32 v25, s19, 16
    s_mov_b32 s19, 107
    v_writelane_b32 v25, s19, 17
    s_mov_b32 s19, 103
    v_writelane_b32 v25, s19, 18
    s_mov_b32 s19, 111
    v_writelane_b32 v25, s19, 19
    s_mov_b32 s19, 101
    v_writelane_b32 v25, s19, 20
    s_mov_b32 s19, 109
    v_writelane_b32 v25, s19, 21
    s_mov_b32 s19, 105
    v_writelane_b32 v25, s19, 22
    s_mov_b32 s19, 113
    v_writelane_b32 v25, s19, 23
L_cn_169:
    s_mov_b32 s60, 200000
L_cw_167:
    ds_read_b32 v20, v16 offset:352
    s_waitcnt lgkmcnt(0)
    v_readfirstlane_b32 s18, v20
    s_add_u32 s18, s18, 2
    s_lshr_b32 s18, s18, 2
    s_cmp_ge_u32 s18, s16
    s_cbranch_scc1 L_cg_168
    s_sleep 1
    s_sub_u32 s60, s60, 1
    s_cbranch_scc0 L_cw_167
L_cg_168:
    s_add_u32 s18, s16, s63
    v_mov_b32 v20, s18
    s_mov_b64 exec, 1
    buffer_store_dword v20, v21, s[40:43], s24 offen
    s_mov_b64 exec, -1
    s_cmp_eq_u32 s16, 24
    s_cbranch_scc1 L_noctl_166
    buffer_load_dword v24, v23, s[40:43], s24 offen sc1
    s_cmp_eq_u32 s16, s23
    s_cbranch_scc0 L_cr_170
    s_mov_b32 s18, 1
    s_atomic_add s18, s[20:21], s17 glc
    s_add_u32 s17, s17, 16384
    s_add_u32 s23, s23, 2
    s_cmp_gt_u32 s23, 23
    s_cselect_b32 s23, 1000, s23
    s_waitcnt lgkmcnt(0)
    s_lshl_b32 s18, s18, 1
    s_add_u32 s18, s18, s63
    v_mov_b32 v20, s18
    s_mov_b64 exec, 1
    buffer_store_dword v20, v22, s[40:43], s24 offen
    s_mov_b64 exec, -1
L_cr_170:
    s_waitcnt vmcnt(0)
    v_subrev_u32 v24, s63, v24
    v_lshrrev_b32 v20, 5, v0
    v_mul_u32_u24 v20, 7, v20
    v_cmp_gt_u32 vcc, 64, v24
    s_nop 1
    v_cndmask_b32 v24, v20, v24, vcc
    s_nop 1
    v_add_u32_dpp v24, v24, v24 quad_perm:[1,0,3,2] row_mask:0xf bank_mask:0xf
    s_nop 1
    v_add_u32_dpp v24, v24, v24 quad_perm:[2,3,0,1] row_mask:0xf bank_mask:0xf
    s_nop 1
    v_add_u32_dpp v24, v24, v24 row_half_mirror row_mask:0xf bank_mask:0xf
    s_nop 1
    v_add_u32_dpp v24, v24, v24 row_mirror row_mask:0xf bank_mask:0xf
    s_nop 0
    v_readlane_b32 s18, v24, 0
    v_readlane_b32 s19, v24, 16
    v_readlane_b32 s26, v24, 32
    s_add_u32 s18, s18, s19
    s_mul_i32 s26, s26, 3
    s_lshr_b32 s26, s26, 2
    s_add_u32 s18, s18, s26
    s_lshl_b32 s19, s16, 5
    s_sub_u32 s18, s18, s19
    s_add_u32 s18, s18, s27
    s_sub_u32 s18, s18, 6
    v_cmp_ge_i32 vcc, s18, v25
    s_add_u32 s18, s18, 4
    s_nop 0
    v_mov_b32 v28, vcc_lo
    v_cmp_ge_i32 vcc, s18, v25
    s_add_u32 s18, s18, 4
    s_nop 0
    v_mov_b32 v29, vcc_lo
    v_cmp_ge_i32 vcc, s18, v25
    s_add_u32 s18, s18, 4
    s_nop 0
    v_mov_b32 v30, vcc_lo
    v_cmp_ge_i32 vcc, s18, v25
    s_add_u32 s18, s18, 4
    s_nop 0
    v_mov_b32 v31, vcc_lo
    s_mov_b64 exec, 1
    ds_write_b128 v16, v[28:31] offset:368
    s_mov_b64 exec, -1
    s_add_u32 s16, s16, 2
    s_cmp_le_u32 s16, 24
    s_cbranch_scc1 L_cn_169
L_noctl_166:
    s_cmp_eq_u32 s3, 0
    s_cbranch_scc0 L_w4_164
    s_mov_b32 s60, 200000
    v_lshrrev_b32 v16, 1, v0
    v_lshlrev_b32 v16, 12, v16
    v_and_b32 v17, 1, v0
    v_lshl_add_u32 v16, v17, 4, v16
    v_add_u32 v16, 1048704, v16
L_chk_171:
    buffer_load_dwordx4 v[20:23], v16, s[40:43], 0 offen sc1
    s_waitcnt vmcnt(0)
    v_xor_b32 v20, s63, v20
    v_xor_b32 v21, s63, v21
    v_xor_b32 v22, s63, v22
    v_xor_b32 v23, s63, v23
    v_or3_b32 v24, v20, v21, v22
    v_or_b32 v24, v24, v23
    v_cmp_lt_u32 vcc, 15, v24
    s_cbranch_vccz L_chkd_172
    s_sleep 32
    s_sub_u32 s60, s60, 1
    s_cbranch_scc0 L_chk_171
L_chkd_172:
    v_lshl_or_b32 v20, v21, 4, v20
    v_lshl_or_b32 v22, v23, 4, v22
    v_lshl_or_b32 v20, v22, 8, v20
    s_nop 0
    v_readlane_b32 s26, v20, 0
    v_readlane_b32 s27, v20, 1
    v_cmp_eq_u32 vcc, 0, v17
    v_mov_b32 v21, s26
    v_mov_b32 v22, s27
    v_cndmask_b32 v21, v22, v21, vcc
    v_cmp_ne_u32 vcc, v20, v21
    s_cmp_eq_u64 vcc, 0
    s_cselect_b32 s27, 1, 0
    s_and_b32 s26, s26, 0x4444
    s_or_b32 s27, s27, s26
    s_bitcmp1_b32 s27, 0
    s_cbranch_scc1 L_noq_173
    buffer_store_dwordx4 v[48:51], v56, s[40:43], 0 offen sc1
L_noq_173:
    s_getreg_b32 s26, hwreg(HW_REG_XCC_ID, 2, 1)
    s_lshl_b32 s26, s26, 1
    s_or_b32 s27, s27, s26
    s_mov_b32 s60, 200000
    v_mov_b32 v16, 0
L_ml_162:
    ds_read_b128 v[24:27], v16 offset:256
    ds_read_b128 v[28:31], v16 offset:272
    s_waitcnt lgkmcnt(0)
    v_max3_u32 v20, v25, v27, v29
    v_max_u32 v20, v20, v31
    v_cmp_eq_u32 vcc, -1, v20
    s_cbranch_vccz L_mld_163
    s_sleep 16
    s_sub_u32 s60, s60, 1
    s_cbranch_scc0 L_ml_162
L_mld_163:
    v_max3_f32 v20, v24, v26, v28
    v_max_f32 v20, v20, v30
    v_sub_f32 v24, v24, v20
    v_sub_f32 v26, v26, v20
    v_sub_f32 v28, v28, v20
    v_sub_f32 v30, v30, v20
    v_mul_f32 v24, s57, v24
    v_mul_f32 v26, s57, v26
    v_mul_f32 v28, s57, v28
    v_mul_f32 v30, s57, v30
    v_exp_f32 v24, v24
    v_exp_f32 v26, v26
    v_exp_f32 v28, v28
    v_exp_f32 v30, v30
    v_mul_f32 v21, v24, v25
    v_fmac_f32 v21, v26, v27
    v_fmac_f32 v21, v28, v29
    v_fmac_f32 v21, v30, v31
    s_mov_b64 exec, 1
    s_bitcmp1_b32 s27, 0
    s_cbranch_scc0 L_mls_174
    buffer_store_dwordx2 v[20:21], v2, s[40:43], 0 offen
L_mlz_175:
    s_mov_b64 exec, -1
    v_and_b32 v17, 0xffffffe0, v2
    v_bfe_u32 v16, v0, 2, 2
    v_lshl_add_u32 v17, v16, 3, v17
    s_mov_b64 exec, 0xffff
    s_mov_b32 s60, 200000
L_poll_176:
    buffer_load_dwordx2 v[22:23], v17, s[40:43], 0 offen sc1
    s_waitcnt vmcnt(0)
    v_max_u32 v16, v22, v23
    v_cmp_eq_u32 vcc, -1, v16
    s_cbranch_vccz L_got_177
    s_sleep 16
    s_sub_u32 s60, s60, 1
    s_cbranch_scc0 L_poll_176
L_got_177:
    v_max_f32_dpp v16, v22, v22 row_ror:4 row_mask:0xf bank_mask:0xf
    s_nop 1
    v_max_f32_dpp v16, v16, v16 row_ror:8 row_mask:0xf bank_mask:0xf
    v_sub_f32 v22, v22, v16
    v_sub_f32 v20, v20, v16
    v_mul_f32 v22, s57, v22
    v_mul_f32 v20, s57, v20
    v_exp_f32 v22, v22
    v_exp_f32 v20, v20
    v_mul_f32 v22, v22, v23
    s_nop 1
    v_add_f32_dpp v22, v22, v22 row_ror:4 row_mask:0xf bank_mask:0xf
    s_nop 1
    v_add_f32_dpp v22, v22, v22 row_ror:8 row_mask:0xf bank_mask:0xf
    v_rcp_f32 v22, v22
    s_nop 0
    v_mul_f32 v20, v20, v22
    s_nop 0
    v_readfirstlane_b32 s60, v20
    s_mov_b64 exec, -1
    s_nop 0
    v_mul_f32 v24, s60, v24
    v_mul_f32 v26, s60, v26
    v_mul_f32 v28, s60, v28
    v_mul_f32 v30, s60, v30
    s_mov_b32 s60, 200000
    v_mov_b32 v16, 1343744
L_pi_178:
    buffer_load_dword v20, v16, s[40:43], 0 offen sc1
    s_waitcnt vmcnt(0)
    v_readfirstlane_b32 s26, v20
    s_xor_b32 s26, s26, s63
    s_cmp_lt_u32 s26, 2
    s_cbranch_scc1 L_pid_179
    s_sleep 32
    s_sub_u32 s60, s60, 1
    s_cbranch_scc0 L_pi_178
L_pid_179:
    s_mul_i32 s26, s26, 0x4446
    s_xor_b32 s27, s27, s26
    v_mov_b32 v16, 0
    v_mov_b32 v20, s27
    ds_write_b32 v16, v20 offset:384
    v_lshlrev_b32 v17, 3, v0
    s_waitcnt lgkmcnt(0)
L_w4_164:
    s_branch L_pg_181
.p2align 12,,800
L_pg_181:
    s_barrier
    s_cmp_eq_u32 s3, 0
    s_cbranch_scc0 L_nw4_182
    s_bitcmp1_b32 s27, 0
    s_barrier
    ds_read2st64_b64 v[32:35], v17 offset0:1 offset1:2
    ds_read2st64_b64 v[36:39], v17 offset0:3 offset1:4
    s_waitcnt lgkmcnt(1)
    v_pk_mul_f32 v[22:23], v[32:33], v[24:25] op_sel_hi:[1,0]
    v_pk_fma_f32 v[22:23], v[34:35], v[26:27], v[22:23] op_sel_hi:[1,0,1]
    s_waitcnt lgkmcnt(0)
    v_pk_fma_f32 v[22:23], v[36:37], v[28:29], v[22:23] op_sel_hi:[1,0,1]
    v_pk_fma_f32 v[22:23], v[38:39], v[30:31], v[22:23] op_sel_hi:[1,0,1]
    v_cvt_pk_bf16_f32 v22, v22, v23
    s_cbranch_scc0 L_slow_180
    buffer_store_dword v22, v1, s[40:43], 0 offen
L_e_165:
    s_endpgm
L_roleW:
    v_lshrrev_b32 v5, 1, v4
    v_and_b32 v16, 1, v4
    v_lshl_add_u32 v5, v5, 2, v16
    v_lshlrev_b32 v5, 8, v5
    v_lshl_add_u32 v5, v3, 2, v5
    s_lshl_b32 s10, s3, 6
    v_add_u32 v5, s10, v5
    ds_read_b32 v64, v5 offset:15872
    ds_read_b32 v72, v5 offset:17920
    ds_read_b32 v65, v5 offset:16384
    ds_read_b32 v73, v5 offset:18432
    ds_read_b32 v66, v5 offset:19968
    ds_read_b32 v74, v5 offset:22016
    ds_read_b32 v67, v5 offset:20480
    ds_read_b32 v75, v5 offset:22528
    s_waitcnt lgkmcnt(0)
    v_perm_b32 v16, v72, v64, s61
    v_perm_b32 v72, v72, v64, s62
    v_mov_b32 v64, v16
    v_perm_b32 v16, v73, v65, s61
    v_perm_b32 v73, v73, v65, s62
    v_mov_b32 v65, v16
    v_perm_b32 v16, v74, v66, s61
    v_perm_b32 v74, v74, v66, s62
    v_mov_b32 v66, v16
    v_perm_b32 v16, v75, v67, s61
    v_perm_b32 v75, v75, v67, s62
    v_mov_b32 v67, v16
    ds_read_b32 v68, v5 offset:24064
    ds_read_b32 v76, v5 offset:26112
    ds_read_b32 v69, v5 offset:24576
    ds_read_b32 v77, v5 offset:26624
    ds_read_b32 v70, v5 offset:28160
    ds_read_b32 v78, v5 offset:30208
    ds_read_b32 v71, v5 offset:28672
    ds_read_b32 v79, v5 offset:30720
    s_waitcnt lgkmcnt(0)
    v_perm_b32 v16, v76, v68, s61
    v_perm_b32 v76, v76, v68, s62
    v_mov_b32 v68, v16
    v_perm_b32 v16, v77, v69, s61
    v_perm_b32 v77, v77, v69, s62
    v_mov_b32 v69, v16
    v_perm_b32 v16, v78, v70, s61
    v_perm_b32 v78, v78, v70, s62
    v_mov_b32 v70, v16
    v_perm_b32 v16, v79, v71, s61
    v_perm_b32 v79, v79, v71, s62
    v_mov_b32 v71, v16
    ds_read_b32 v80, v5 offset:32256
    ds_read_b32 v88, v5 offset:34304
    ds_read_b32 v81, v5 offset:32768
    ds_read_b32 v89, v5 offset:34816
    ds_read_b32 v82, v5 offset:36352
    ds_read_b32 v90, v5 offset:38400
    ds_read_b32 v83, v5 offset:36864
    ds_read_b32 v91, v5 offset:38912
    s_waitcnt lgkmcnt(0)
    v_perm_b32 v16, v88, v80, s61
    v_perm_b32 v88, v88, v80, s62
    v_mov_b32 v80, v16
    v_perm_b32 v16, v89, v81, s61
    v_perm_b32 v89, v89, v81, s62
    v_mov_b32 v81, v16
    v_perm_b32 v16, v90, v82, s61
    v_perm_b32 v90, v90, v82, s62
    v_mov_b32 v82, v16
    v_perm_b32 v16, v91, v83, s61
    v_perm_b32 v91, v91, v83, s62
    v_mov_b32 v83, v16
    ds_read_b32 v84, v5 offset:40448
    ds_read_b32 v92, v5 offset:42496
    ds_read_b32 v85, v5 offset:40960
    ds_read_b32 v93, v5 offset:43008
    ds_read_b32 v86, v5 offset:44544
    ds_read_b32 v94, v5 offset:46592
    ds_read_b32 v87, v5 offset:45056
    ds_read_b32 v95, v5 offset:47104
    s_waitcnt lgkmcnt(0)
    v_perm_b32 v16, v92, v84, s61
    v_perm_b32 v92, v92, v84, s62
    v_mov_b32 v84, v16
    v_perm_b32 v16, v93, v85, s61
    v_perm_b32 v93, v93, v85, s62
    v_mov_b32 v85, v16
    v_perm_b32 v16, v94, v86, s61
    v_perm_b32 v94, v94, v86, s62
    v_mov_b32 v86, v16
    v_perm_b32 v16, v95, v87, s61
    v_perm_b32 v95, v95, v87, s62
    v_mov_b32 v87, v16
    v_bfe_u32 v15, v0, 0, 1
    v_mul_u32_u24 v15, 0xaaaa, v15
    v_add_u32 v15, 0x4444, v15
    v_mov_b32 v96, 0
    v_mov_b32 v97, 0
    v_mov_b32 v98, 0
    v_mov_b32 v99, 0
    v_mov_b32 v100, 0
    v_mov_b32 v101, 0
    v_mov_b32 v102, 0
    v_mov_b32 v103, 0
    s_cmp_eq_u32 s3, 1
    s_cbranch_scc0 L_nox
    s_lshr_b32 s10, s2, 3
    s_lshl_b32 s10, s10, 6
    v_lshrrev_b32 v9, 5, v0
    v_mul_u32_u24 v9, 1280, v9
    v_lshl_add_u32 v9, v3, 2, v9
    v_and_b32 v10, 1, v4
    v_lshl_add_u32 v9, v10, 1, v9
    buffer_load_ushort v10, v9, s[44:47], s10 offen
    v_lshlrev_b32 v9, 2, v0
    s_waitcnt vmcnt(0)
    v_lshlrev_b32 v10, 16, v10
    ds_write_b32 v9, v10 offset:3584
    s_waitcnt lgkmcnt(0)
L_nox:
    v_lshlrev_b32 v9, 4, v0
    s_lshl_b32 s12, s4, 11
    s_add_u32 s12, s12, 1835008
    s_lshl_b32 s13, s4, 7
    s_lshl_b32 s15, s9, 16
    s_add_u32 s13, s13, s15
    s_lshl_b32 s15, s3, 14
    s_add_u32 s13, s13, s15
    s_add_u32 s13, s13, 1376256
    v_lshlrev_b32 v11, 2, v3
    v_and_b32 v6, 1, v4
    v_lshl_add_u32 v11, v6, 12, v11
    v_lshrrev_b32 v6, 1, v4
    v_lshl_add_u32 v11, v6, 6, v11
    s_add_u32 s22, s13, 8192
    s_cmp_ge_u32 s3, 2
    s_cbranch_scc0 L_noctl_189
    s_lshr_b32 s18, s2, 3
    s_mul_i32 s19, s18, 205
    s_lshr_b32 s19, s19, 10
    s_mov_b32 s23, 1000
    s_mul_i32 s17, s19, 5
    s_add_u32 s17, s17, 2
    s_cmp_eq_u32 s17, s18
    s_cbranch_scc0 L_cr_193x
    s_cmp_eq_u32 s3, 2
    s_cbranch_scc0 L_cr_193x
    s_mov_b32 s23, 1
    s_mov_b32 s60, 200000
    v_lshrrev_b32 v16, 1, v0
    v_lshlrev_b32 v16, 12, v16
    v_and_b32 v17, 1, v0
    v_lshl_add_u32 v16, v17, 4, v16
    v_add_u32 v16, 1048704, v16
L_chk_194:
    buffer_load_dwordx4 v[20:23], v16, s[40:43], 0 offen sc1
    s_waitcnt vmcnt(0)
    v_xor_b32 v20, s63, v20
    v_xor_b32 v21, s63, v21
    v_xor_b32 v22, s63, v22
    v_xor_b32 v23, s63, v23
    v_or3_b32 v24, v20, v21, v22
    v_or_b32 v24, v24, v23
    v_cmp_lt_u32 vcc, 15, v24
    s_cbranch_vccz L_chkd_195
    s_sleep 32
    s_sub_u32 s60, s60, 1
    s_cbranch_scc0 L_chk_194
L_chkd_195:
L_cr_193x:
    s_lshl_b32 s17, s19, 12
    s_add_u32 s20, s38, 1048576
    s_addc_u32 s21, s39, 0
    s_and_b32 s24, s2, 7
    s_cmp_ge_u32 s24, 3
    s_cselect_b32 s27, 0, 0
    s_and_b32 s24, s2, 7
    s_lshl_b32 s24, s24, 12
    s_add_u32 s24, s24, 1312768
    s_lshl_b32 s18, s18, 2
    s_lshl_b32 s19, s19, 2
    s_add_u32 s19, s19, 128
    v_mov_b32 v21, s18
    v_mov_b32 v22, s19
    v_mov_b32 v16, 0
    v_lshlrev_b32 v17, 3, v0
    v_lshlrev_b32 v23, 2, v0
    s_sub_u32 s16, s3, 1
    v_mov_b32 v25, 0x7fffffff
    v_writelane_b32 v25, 60, 0
    s_mov_b32 s19, 72
    v_writelane_b32 v25, s19, 1
    s_mov_b32 s19, 66
    v_writelane_b32 v25, s19, 2
    s_mov_b32 s19, 78
    v_writelane_b32 v25, s19, 3
    v_writelane_b32 v25, 63, 4
    s_mov_b32 s19, 75
    v_writelane_b32 v25, s19, 5
    s_mov_b32 s19, 69
    v_writelane_b32 v25, s19, 6
    s_mov_b32 s19, 81
    v_writelane_b32 v25, s19, 7
    s_mov_b32 s19, 83
    v_writelane_b32 v25, s19, 8
    s_mov_b32 s19, 91
    v_writelane_b32 v25, s19, 9
    s_mov_b32 s19, 87
    v_writelane_b32 v25, s19, 10
    s_mov_b32 s19, 95
    v_writelane_b32 v25, s19, 11
    s_mov_b32 s19, 85
    v_writelane_b32 v25, s19, 12
    s_mov_b32 s19, 93
    v_writelane_b32 v25, s19, 13
    s_mov_b32 s19, 89
    v_writelane_b32 v25, s19, 14
    s_mov_b32 s19, 97
    v_writelane_b32 v25, s19, 15
    s_mov_b32 s19, 99
    v_writelane_b32 v25, s19, 16
    s_mov_b32 s19, 107
    v_writelane_b32 v25, s19, 17
    s_mov_b32 s19, 103
    v_writelane_b32 v25, s19, 18
    s_mov_b32 s19, 111
    v_writelane_b32 v25, s19, 19
    s_mov_b32 s19, 101
    v_writelane_b32 v25, s19, 20
    s_mov_b32 s19, 109
    v_writelane_b32 v25, s19, 21
    s_mov_b32 s19, 105
    v_writelane_b32 v25, s19, 22
    s_mov_b32 s19, 113
    v_writelane_b32 v25, s19, 23
L_cn_192:
    s_mov_b32 s60, 200000
L_cw_190:
    ds_read_b32 v20, v16 offset:352
    s_waitcnt lgkmcnt(0)
    v_readfirstlane_b32 s18, v20
    s_add_u32 s18, s18, 2
    s_lshr_b32 s18, s18, 2
    s_cmp_ge_u32 s18, s16
    s_cbranch_scc1 L_cg_191
    s_sleep 1
    s_sub_u32 s60, s60, 1
    s_cbranch_scc0 L_cw_190
L_cg_191:
    s_add_u32 s18, s16, s63
    v_mov_b32 v20, s18
    s_mov_b64 exec, 1
    buffer_store_dword v20, v21, s[40:43], s24 offen
    s_mov_b64 exec, -1
    buffer_load_dword v24, v23, s[40:43], s24 offen sc1
    s_cmp_eq_u32 s16, s23
    s_cbranch_scc0 L_cr_193
    s_mov_b32 s18, 1
    s_atomic_add s18, s[20:21], s17 glc
    s_add_u32 s17, s17, 16384
    s_add_u32 s23, s23, 2
    s_cmp_gt_u32 s23, 23
    s_cselect_b32 s23, 1000, s23
    s_waitcnt lgkmcnt(0)
    s_lshl_b32 s18, s18, 1
    s_add_u32 s18, s18, s63
    v_mov_b32 v20, s18
    s_mov_b64 exec, 1
    buffer_store_dword v20, v22, s[40:43], s24 offen
    s_mov_b64 exec, -1
L_cr_193:
    s_waitcnt vmcnt(0)
    v_subrev_u32 v24, s63, v24
    v_lshrrev_b32 v20, 5, v0
    v_mul_u32_u24 v20, 7, v20
    v_cmp_gt_u32 vcc, 64, v24
    s_nop 1
    v_cndmask_b32 v24, v20, v24, vcc
    s_nop 1
    v_add_u32_dpp v24, v24, v24 quad_perm:[1,0,3,2] row_mask:0xf bank_mask:0xf
    s_nop 1
    v_add_u32_dpp v24, v24, v24 quad_perm:[2,3,0,1] row_mask:0xf bank_mask:0xf
    s_nop 1
    v_add_u32_dpp v24, v24, v24 row_half_mirror row_mask:0xf bank_mask:0xf
    s_nop 1
    v_add_u32_dpp v24, v24, v24 row_mirror row_mask:0xf bank_mask:0xf
    s_nop 0
    v_readlane_b32 s18, v24, 0
    v_readlane_b32 s19, v24, 16
    v_readlane_b32 s26, v24, 32
    s_add_u32 s18, s18, s19
    s_mul_i32 s26, s26, 3
    s_lshr_b32 s26, s26, 2
    s_add_u32 s18, s18, s26
    s_lshl_b32 s19, s16, 5
    s_sub_u32 s18, s18, s19
    s_add_u32 s18, s18, s27
    s_sub_u32 s18, s18, 6
    v_cmp_ge_i32 vcc, s18, v25
    s_add_u32 s18, s18, 4
    s_nop 0
    v_mov_b32 v28, vcc_lo
    v_cmp_ge_i32 vcc, s18, v25
    s_add_u32 s18, s18, 4
    s_nop 0
    v_mov_b32 v29, vcc_lo
    v_cmp_ge_i32 vcc, s18, v25
    s_add_u32 s18, s18, 4
    s_nop 0
    v_mov_b32 v30, vcc_lo
    v_cmp_ge_i32 vcc, s18, v25
    s_add_u32 s18, s18, 4
    s_nop 0
    v_mov_b32 v31, vcc_lo
    s_mov_b64 exec, 1
    ds_write_b128 v16, v[28:31] offset:368
    s_mov_b64 exec, -1
    s_add_u32 s16, s16, 2
    s_cmp_le_u32 s16, 24
    s_cbranch_scc1 L_cn_192
L_noctl_189:
    s_cmp_eq_u32 s3, 0
    s_cbranch_scc0 L_w4_187
    s_mov_b32 s60, 200000
    v_lshrrev_b32 v16, 1, v0
    v_lshlrev_b32 v16, 12, v16
    v_and_b32 v17, 1, v0
    v_lshl_add_u32 v16, v17, 4, v16
    v_add_u32 v16, 1048704, v16
L_chk_196:
    buffer_load_dwordx4 v[20:23], v16, s[40:43], 0 offen sc1
    s_waitcnt vmcnt(0)
    v_xor_b32 v20, s63, v20
    v_xor_b32 v21, s63, v21
    v_xor_b32 v22, s63, v22
    v_xor_b32 v23, s63, v23
    v_or3_b32 v24, v20, v21, v22
    v_or_b32 v24, v24, v23
    v_cmp_lt_u32 vcc, 15, v24
    s_cbranch_vccz L_chkd_197
    s_sleep 32
    s_sub_u32 s60, s60, 1
    s_cbranch_scc0 L_chk_196
L_chkd_197:
    v_lshl_or_b32 v20, v21, 4, v20
    v_lshl_or_b32 v22, v23, 4, v22
    v_lshl_or_b32 v20, v22, 8, v20
    s_nop 0
    v_readlane_b32 s26, v20, 0
    v_readlane_b32 s27, v20, 1
    v_cmp_eq_u32 vcc, 0, v17
    v_mov_b32 v21, s26
    v_mov_b32 v22, s27
    v_cndmask_b32 v21, v22, v21, vcc
    v_cmp_ne_u32 vcc, v20, v21
    s_cmp_eq_u64 vcc, 0
    s_cselect_b32 s27, 1, 0
    s_and_b32 s26, s26, 0x4444
    s_or_b32 s27, s27, s26
    s_bitcmp1_b32 s27, 0
    s_cbranch_scc1 L_noq_198
    buffer_store_dwordx4 v[48:51], v56, s[40:43], 0 offen sc1
L_noq_198:
    s_getreg_b32 s26, hwreg(HW_REG_XCC_ID, 2, 1)
    s_lshl_b32 s26, s26, 1
    s_or_b32 s27, s27, s26
    s_mov_b32 s60, 200000
    v_mov_b32 v16, 0
L_ml_185:
    ds_read_b128 v[24:27], v16 offset:256
    ds_read_b128 v[28:31], v16 offset:272
    s_waitcnt lgkmcnt(0)
    v_max3_u32 v20, v25, v27, v29
    v_max_u32 v20, v20, v31
    v_cmp_eq_u32 vcc, -1, v20
    s_cbranch_vccz L_mld_186
    s_sleep 16
    s_sub_u32 s60, s60, 1
    s_cbranch_scc0 L_ml_185
L_mld_186:
    v_max3_f32 v20, v24, v26, v28
    v_max_f32 v20, v20, v30
    v_sub_f32 v24, v24, v20
    v_sub_f32 v26, v26, v20
    v_sub_f32 v28, v28, v20
    v_sub_f32 v30, v30, v20
    v_mul_f32 v24, s57, v24
    v_mul_f32 v26, s57, v26
    v_mul_f32 v28, s57, v28
    v_mul_f32 v30, s57, v30
    v_exp_f32 v24, v24
    v_exp_f32 v26, v26
    v_exp_f32 v28, v28
    v_exp_f32 v30, v30
    v_mul_f32 v21, v24, v25
    v_fmac_f32 v21, v26, v27
    v_fmac_f32 v21, v28, v29
    v_fmac_f32 v21, v30, v31
    s_mov_b64 exec, 1
    s_bitcmp1_b32 s27, 0
    s_cbranch_scc0 L_mls_199
    buffer_store_dwordx2 v[20:21], v2, s[40:43], 0 offen
L_mlz_200:
    s_mov_b64 exec, -1
    v_and_b32 v17, 0xffffffe0, v2
    v_bfe_u32 v16, v0, 2, 2
    v_lshl_add_u32 v17, v16, 3, v17
    s_mov_b64 exec, 0xffff
    s_mov_b32 s60, 200000
L_poll_201:
    buffer_load_dwordx2 v[22:23], v17, s[40:43], 0 offen sc1
    s_waitcnt vmcnt(0)
    v_max_u32 v16, v22, v23
    v_cmp_eq_u32 vcc, -1, v16
    s_cbranch_vccz L_got_202
    s_sleep 16
    s_sub_u32 s60, s60, 1
    s_cbranch_scc0 L_poll_201
L_got_202:
    v_max_f32_dpp v16, v22, v22 row_ror:4 row_mask:0xf bank_mask:0xf
    s_nop 1
    v_max_f32_dpp v16, v16, v16 row_ror:8 row_mask:0xf bank_mask:0xf
    v_sub_f32 v22, v22, v16
    v_sub_f32 v20, v20, v16
    v_mul_f32 v22, s57, v22
    v_mul_f32 v20, s57, v20
    v_exp_f32 v22, v22
    v_exp_f32 v20, v20
    v_mul_f32 v22, v22, v23
    s_nop 1
    v_add_f32_dpp v22, v22, v22 row_ror:4 row_mask:0xf bank_mask:0xf
    s_nop 1
    v_add_f32_dpp v22, v22, v22 row_ror:8 row_mask:0xf bank_mask:0xf
    v_rcp_f32 v22, v22
    s_nop 0
    v_mul_f32 v20, v20, v22
    s_nop 0
    v_readfirstlane_b32 s60, v20
    s_mov_b64 exec, -1
    s_nop 0
    v_mul_f32 v24, s60, v24
    v_mul_f32 v26, s60, v26
    v_mul_f32 v28, s60, v28
    v_mul_f32 v30, s60, v30
    s_mov_b32 s60, 200000
    v_mov_b32 v16, 1343744
L_pi_203:
    buffer_load_dword v20, v16, s[40:43], 0 offen sc1
    s_waitcnt vmcnt(0)
    v_readfirstlane_b32 s26, v20
    s_xor_b32 s26, s26, s63
    s_cmp_lt_u32 s26, 2
    s_cbranch_scc1 L_pid_204
    s_sleep 32
    s_sub_u32 s60, s60, 1
    s_cbranch_scc0 L_pi_203
L_pid_204:
    s_mul_i32 s26, s26, 0x4446
    s_xor_b32 s27, s27, s26
    v_mov_b32 v16, 0
    v_mov_b32 v20, s27
    ds_write_b32 v16, v20 offset:384
    v_lshlrev_b32 v17, 3, v0
    s_waitcnt lgkmcnt(0)
L_w4_187:
    s_branch L_pg_206
.p2align 12,,800
L_pg_206:
    s_barrier
    s_cmp_eq_u32 s3, 0
    s_cbranch_scc0 L_nw4_207
    s_bitcmp1_b32 s27, 0
    s_barrier
    ds_read2st64_b64 v[32:35], v17 offset0:1 offset1:2
    ds_read2st64_b64 v[36:39], v17 offset0:3 offset1:4
    s_waitcnt lgkmcnt(1)
    v_pk_mul_f32 v[22:23], v[32:33], v[24:25] op_sel_hi:[1,0]
    v_pk_fma_f32 v[22:23], v[34:35], v[26:27], v[22:23] op_sel_hi:[1,0,1]
    s_waitcnt lgkmcnt(0)
    v_pk_fma_f32 v[22:23], v[36:37], v[28:29], v[22:23] op_sel_hi:[1,0,1]
    v_pk_fma_f32 v[22:23], v[38:39], v[30:31], v[22:23] op_sel_hi:[1,0,1]
    v_cvt_pk_bf16_f32 v22, v22, v23
    s_cbranch_scc0 L_slow_205
    buffer_store_dword v22, v1, s[40:43], 0 offen
L_e_188:
    s_barrier
    s_mov_b32 s60, 200000
    buffer_load_dwordx4 v[40:43], v9, s[40:43], s12 offen sc1
    buffer_load_dwordx4 v[44:47], v9, s[40:43], s12 offen offset:1024 sc1
    s_sleep 2
L_poll_208:
    buffer_load_dwordx4 v[48:51], v9, s[40:43], s12 offen sc1
    buffer_load_dwordx4 v[52:55], v9, s[40:43], s12 offen offset:1024 sc1
    s_sub_u32 s60, s60, 1
    s_cbranch_scc1 L_end
    s_waitcnt vmcnt(2)
    v_max_u32 v16, v40, v41
    v_max3_u32 v16, v16, v42, v43
    v_max3_u32 v16, v16, v44, v45
    v_max3_u32 v16, v16, v46, v47
    v_cmp_eq_u32 vcc, -1, v16
    s_cbranch_vccz L_gotA_209
    buffer_load_dwordx4 v[40:43], v9, s[40:43], s12 offen sc1
    buffer_load_dwordx4 v[44:47], v9, s[40:43], s12 offen offset:1024 sc1
    s_waitcnt vmcnt(2)
    v_max_u32 v16, v48, v49
    v_max3_u32 v16, v16, v50, v51
    v_max3_u32 v16, v16, v52, v53
    v_max3_u32 v16, v16, v54, v55
    v_cmp_eq_u32 vcc, -1, v16
    s_cbranch_vccnz L_poll_208
    v_smfmac_f32_16x16x64_bf16 v[96:99], v[48:51], v[64:71], v15
    v_smfmac_f32_16x16x64_bf16 v[100:103], v[48:51], v[72:79], v15
    v_smfmac_f32_16x16x64_bf16 v[96:99], v[52:55], v[80:87], v15
    v_smfmac_f32_16x16x64_bf16 v[100:103], v[52:55], v[88:95], v15
    s_branch L_got_210
L_gotA_209:
    v_smfmac_f32_16x16x64_bf16 v[96:99], v[40:43], v[64:71], v15
    v_smfmac_f32_16x16x64_bf16 v[100:103], v[40:43], v[72:79], v15
    v_smfmac_f32_16x16x64_bf16 v[96:99], v[44:47], v[80:87], v15
    v_smfmac_f32_16x16x64_bf16 v[100:103], v[44:47], v[88:95], v15
L_got_210:
    s_nop 6
    v_add_f32 v16, v96, v97
    v_add_f32 v18, v98, v99
    v_add_f32 v17, v100, v101
    v_add_f32 v19, v102, v103
    s_nop 0
    v_permlane32_swap_b32 v16, v17
    v_permlane32_swap_b32 v18, v19
    v_add_f32 v16, v16, v17
    v_add_f32 v18, v18, v19
    s_nop 1
    v_permlane16_swap_b32 v16, v18
    v_add_f32 v16, v16, v18
    buffer_store_dword v16, v11, s[40:43], s22 offen sc1
    buffer_store_dword v16, v11, s[40:43], s13 offen sc1
    s_barrier
    s_endpgm
L_roleG:
    s_bitcmp1_b32 s9, 0
    s_cselect_b64 s[48:49], s[30:31], s[28:29]
    s_cselect_b64 s[52:53], s[28:29], s[30:31]
    s_and_b32 s49, s49, 0xffff
    s_and_b32 s53, s53, 0xffff
    s_mov_b32 s50, 2211840
    s_mov_b32 s51, 0x20000
    s_mov_b32 s54, 2211840
    s_mov_b32 s55, 0x20000
    v_lshrrev_b32 v5, 2, v0
    v_mul_u32_u24 v5, 6912, v5
    v_and_b32 v6, 3, v0
    v_lshl_add_u32 v5, v6, 4, v5
    s_mul_i32 s15, s3, 552960
    s_lshl_b32 s10, s9, 6
    s_add_u32 s15, s15, s10
    s_and_b32 s11, s2, 7
    s_lshl_b32 s11, s11, 13
    s_lshl_b32 s10, s3, 10
    s_add_u32 s11, s11, s10
    s_add_u32 s11, s11, 1769472
    v_min_u32 v6, 11, v3
    v_lshlrev_b32 v6, 4, v6
    v_lshl_add_u32 v6, v4, 8, v6
    v_and_b32 v7, 14, v3
    v_cmp_eq_u32 vcc, 2, v7
    v_mov_b32 v7, 0x40000000
    s_nop 0
    v_cndmask_b32 v6, v6, v7, vcc
    v_bfe_u32 v59, v0, 1, 1
    v_mul_u32_u24 v59, 0xaaaa, v59
    v_add_u32 v59, 0x4444, v59
    s_lshl_b32 s10, s3, 9
    s_add_u32 s10, s10, 3584
    v_lshl_add_u32 v11, v3, 3, s10
    s_and_b32 s10, s9, 1
    s_lshl_b32 s10, s10, 2
    v_add_u32 v11, s10, v11
    v_xor_b32 v14, 4, v11
    v_and_b32 v12, 1, v0
    v_lshlrev_b32 v12, 14, v12
    v_lshrrev_b32 v13, 1, v0
    v_lshl_add_u32 v12, v13, 2, v12
    s_lshl_b32 s10, s9, 7
    s_add_u32 s10, s10, 1703936
    v_add_u32 v12, s10, v12
    v_lshlrev_b32 v13, 3, v0
    v_lshrrev_b32 v7, 5, v0
    v_lshlrev_b32 v7, 3, v7
    s_mov_b32 s12, 32768
    v_mov_b32 v40, s58
    v_mov_b32 v41, s58
    v_mov_b32 v42, s58
    v_mov_b32 v43, s58
    v_lshrrev_b32 v15, 2, v3
    v_lshl_add_u32 v15, v4, 3, v15
    v_lshlrev_b32 v15, 6, v15
    v_and_b32 v16, 3, v0
    v_lshl_add_u32 v15, v16, 3, v15
    s_mul_i32 s10, s3, 20480
    s_add_u32 s10, s10, 15872
    v_add_u32 v15, s10, v15
    v_mov_b32 v18, 0xc0135761
    v_add_u32 v8, 2048, v11
    v_add_u32 v9, 2048, v14
    s_cmp_ge_u32 s3, 2
    s_cbranch_scc0 L_noctl_217
    s_lshr_b32 s18, s2, 3
    s_mul_i32 s19, s18, 205
    s_lshr_b32 s19, s19, 10
    s_mov_b32 s23, 1000
    s_lshl_b32 s17, s19, 12
    s_add_u32 s20, s38, 1048576
    s_addc_u32 s21, s39, 0
    s_and_b32 s24, s2, 7
    s_cmp_ge_u32 s24, 3
    s_cselect_b32 s27, 0, 0
    s_and_b32 s24, s2, 7
    s_lshl_b32 s24, s24, 12
    s_add_u32 s24, s24, 1312768
    s_lshl_b32 s18, s18, 2
    s_lshl_b32 s19, s19, 2
    s_add_u32 s19, s19, 128
    v_mov_b32 v21, s18
    v_mov_b32 v22, s19
    v_mov_b32 v16, 0
    v_lshlrev_b32 v17, 3, v0
    v_lshlrev_b32 v23, 2, v0
    s_sub_u32 s16, s3, 1
    v_mov_b32 v25, 0x7fffffff
    v_writelane_b32 v25, 60, 0
    s_mov_b32 s19, 72
    v_writelane_b32 v25, s19, 1
    s_mov_b32 s19, 66
    v_writelane_b32 v25, s19, 2
    s_mov_b32 s19, 78
    v_writelane_b32 v25, s19, 3
    v_writelane_b32 v25, 63, 4
    s_mov_b32 s19, 75
    v_writelane_b32 v25, s19, 5
    s_mov_b32 s19, 69
    v_writelane_b32 v25, s19, 6
    s_mov_b32 s19, 81
    v_writelane_b32 v25, s19, 7
    s_mov_b32 s19, 83
    v_writelane_b32 v25, s19, 8
    s_mov_b32 s19, 91
    v_writelane_b32 v25, s19, 9
    s_mov_b32 s19, 87
    v_writelane_b32 v25, s19, 10
    s_mov_b32 s19, 95
    v_writelane_b32 v25, s19, 11
    s_mov_b32 s19, 85
    v_writelane_b32 v25, s19, 12
    s_mov_b32 s19, 93
    v_writelane_b32 v25, s19, 13
    s_mov_b32 s19, 89
    v_writelane_b32 v25, s19, 14
    s_mov_b32 s19, 97
    v_writelane_b32 v25, s19, 15
    s_mov_b32 s19, 99
    v_writelane_b32 v25, s19, 16
    s_mov_b32 s19, 107
    v_writelane_b32 v25, s19, 17
    s_mov_b32 s19, 103
    v_writelane_b32 v25, s19, 18
    s_mov_b32 s19, 111
    v_writelane_b32 v25, s19, 19
    s_mov_b32 s19, 101
    v_writelane_b32 v25, s19, 20
    s_mov_b32 s19, 109
    v_writelane_b32 v25, s19, 21
    s_mov_b32 s19, 105
    v_writelane_b32 v25, s19, 22
    s_mov_b32 s19, 113
    v_writelane_b32 v25, s19, 23
L_cn_220:
    s_mov_b32 s60, 200000
L_cw_218:
    ds_read_b32 v20, v16 offset:352
    s_waitcnt lgkmcnt(0)
    v_readfirstlane_b32 s18, v20
    s_add_u32 s18, s18, 2
    s_lshr_b32 s18, s18, 2
    s_cmp_ge_u32 s18, s16
    s_cbranch_scc1 L_cg_219
    s_sleep 1
    s_sub_u32 s60, s60, 1
    s_cbranch_scc0 L_cw_218
L_cg_219:
    s_add_u32 s18, s16, s63
    v_mov_b32 v20, s18
    s_mov_b64 exec, 1
    buffer_store_dword v20, v21, s[40:43], s24 offen
    s_mov_b64 exec, -1
    s_cmp_eq_u32 s16, 24
    s_cbranch_scc1 L_noctl_217
    buffer_load_dword v24, v23, s[40:43], s24 offen sc1
    s_cmp_eq_u32 s16, s23
    s_cbranch_scc0 L_cr_221
    s_mov_b32 s18, 1
    s_atomic_add s18, s[20:21], s17 glc
    s_add_u32 s17, s17, 16384
    s_add_u32 s23, s23, 2
    s_cmp_gt_u32 s23, 23
    s_cselect_b32 s23, 1000, s23
    s_waitcnt lgkmcnt(0)
    s_lshl_b32 s18, s18, 1
    s_add_u32 s18, s18, s63
    v_mov_b32 v20, s18
    s_mov_b64 exec, 1
    buffer_store_dword v20, v22, s[40:43], s24 offen
    s_mov_b64 exec, -1
L_cr_221:
    s_waitcnt vmcnt(0)
    v_subrev_u32 v24, s63, v24
    v_lshrrev_b32 v20, 5, v0
    v_mul_u32_u24 v20, 7, v20
    v_cmp_gt_u32 vcc, 64, v24
    s_nop 1
    v_cndmask_b32 v24, v20, v24, vcc
    s_nop 1
    v_add_u32_dpp v24, v24, v24 quad_perm:[1,0,3,2] row_mask:0xf bank_mask:0xf
    s_nop 1
    v_add_u32_dpp v24, v24, v24 quad_perm:[2,3,0,1] row_mask:0xf bank_mask:0xf
    s_nop 1
    v_add_u32_dpp v24, v24, v24 row_half_mirror row_mask:0xf bank_mask:0xf
    s_nop 1
    v_add_u32_dpp v24, v24, v24 row_mirror row_mask:0xf bank_mask:0xf
    s_nop 0
    v_readlane_b32 s18, v24, 0
    v_readlane_b32 s19, v24, 16
    v_readlane_b32 s26, v24, 32
    s_add_u32 s18, s18, s19
    s_mul_i32 s26, s26, 3
    s_lshr_b32 s26, s26, 2
    s_add_u32 s18, s18, s26
    s_lshl_b32 s19, s16, 5
    s_sub_u32 s18, s18, s19
    s_add_u32 s18, s18, s27
    s_sub_u32 s18, s18, 6
    v_cmp_ge_i32 vcc, s18, v25
    s_add_u32 s18, s18, 4
    s_nop 0
    v_mov_b32 v28, vcc_lo
    v_cmp_ge_i32 vcc, s18, v25
    s_add_u32 s18, s18, 4
    s_nop 0
    v_mov_b32 v29, vcc_lo
    v_cmp_ge_i32 vcc, s18, v25
    s_add_u32 s18, s18, 4
    s_nop 0
    v_mov_b32 v30, vcc_lo
    v_cmp_ge_i32 vcc, s18, v25
    s_add_u32 s18, s18, 4
    s_nop 0
    v_mov_b32 v31, vcc_lo
    s_mov_b64 exec, 1
    ds_write_b128 v16, v[28:31] offset:368
    s_mov_b64 exec, -1
    s_add_u32 s16, s16, 2
    s_cmp_le_u32 s16, 24
    s_cbranch_scc1 L_cn_220
L_noctl_217:
    s_cmp_eq_u32 s3, 0
    s_cbranch_scc0 L_w4_215
    s_mov_b32 s60, 200000
    v_lshrrev_b32 v16, 1, v0
    v_lshlrev_b32 v16, 12, v16
    v_and_b32 v17, 1, v0
    v_lshl_add_u32 v16, v17, 4, v16
    v_add_u32 v16, 1048704, v16
L_chk_222:
    buffer_load_dwordx4 v[20:23], v16, s[40:43], 0 offen sc1
    s_waitcnt vmcnt(0)
    v_xor_b32 v20, s63, v20
    v_xor_b32 v21, s63, v21
    v_xor_b32 v22, s63, v22
    v_xor_b32 v23, s63, v23
    v_or3_b32 v24, v20, v21, v22
    v_or_b32 v24, v24, v23
    v_cmp_lt_u32 vcc, 15, v24
    s_cbranch_vccz L_chkd_223
    s_sleep 32
    s_sub_u32 s60, s60, 1
    s_cbranch_scc0 L_chk_222
L_chkd_223:
    v_lshl_or_b32 v20, v21, 4, v20
    v_lshl_or_b32 v22, v23, 4, v22
    v_lshl_or_b32 v20, v22, 8, v20
    s_nop 0
    v_readlane_b32 s26, v20, 0
    v_readlane_b32 s27, v20, 1
    v_cmp_eq_u32 vcc, 0, v17
    v_mov_b32 v21, s26
    v_mov_b32 v22, s27
    v_cndmask_b32 v21, v22, v21, vcc
    v_cmp_ne_u32 vcc, v20, v21
    s_cmp_eq_u64 vcc, 0
    s_cselect_b32 s27, 1, 0
    s_and_b32 s26, s26, 0x4444
    s_or_b32 s27, s27, s26
    s_bitcmp1_b32 s27, 0
    s_cbranch_scc1 L_noq_224
    buffer_store_dwordx4 v[48:51], v56, s[40:43], 0 offen sc1
L_noq_224:
    s_getreg_b32 s26, hwreg(HW_REG_XCC_ID, 2, 1)
    s_lshl_b32 s26, s26, 1
    s_or_b32 s27, s27, s26
    s_mov_b32 s60, 200000
    v_mov_b32 v16, 0
L_ml_213:
    ds_read_b128 v[24:27], v16 offset:256
    ds_read_b128 v[28:31], v16 offset:272
    s_waitcnt lgkmcnt(0)
    v_max3_u32 v20, v25, v27, v29
    v_max_u32 v20, v20, v31
    v_cmp_eq_u32 vcc, -1, v20
    s_cbranch_vccz L_mld_214
    s_sleep 16
    s_sub_u32 s60, s60, 1
    s_cbranch_scc0 L_ml_213
L_mld_214:
    v_max3_f32 v20, v24, v26, v28
    v_max_f32 v20, v20, v30
    v_sub_f32 v24, v24, v20
    v_sub_f32 v26, v26, v20
    v_sub_f32 v28, v28, v20
    v_sub_f32 v30, v30, v20
    v_mul_f32 v24, s57, v24
    v_mul_f32 v26, s57, v26
    v_mul_f32 v28, s57, v28
    v_mul_f32 v30, s57, v30
    v_exp_f32 v24, v24
    v_exp_f32 v26, v26
    v_exp_f32 v28, v28
    v_exp_f32 v30, v30
    v_mul_f32 v21, v24, v25
    v_fmac_f32 v21, v26, v27
    v_fmac_f32 v21, v28, v29
    v_fmac_f32 v21, v30, v31
    s_mov_b64 exec, 1
    s_bitcmp1_b32 s27, 0
    s_cbranch_scc0 L_mls_225
    buffer_store_dwordx2 v[20:21], v2, s[40:43], 0 offen
L_mlz_226:
    s_mov_b64 exec, -1
    v_and_b32 v17, 0xffffffe0, v2
    v_bfe_u32 v16, v0, 2, 2
    v_lshl_add_u32 v17, v16, 3, v17
    s_mov_b64 exec, 0xffff
    s_mov_b32 s60, 200000
L_poll_227:
    buffer_load_dwordx2 v[22:23], v17, s[40:43], 0 offen sc1
    s_waitcnt vmcnt(0)
    v_max_u32 v16, v22, v23
    v_cmp_eq_u32 vcc, -1, v16
    s_cbranch_vccz L_got_228
    s_sleep 16
    s_sub_u32 s60, s60, 1
    s_cbranch_scc0 L_poll_227
L_got_228:
    v_max_f32_dpp v16, v22, v22 row_ror:4 row_mask:0xf bank_mask:0xf
    s_nop 1
    v_max_f32_dpp v16, v16, v16 row_ror:8 row_mask:0xf bank_mask:0xf
    v_sub_f32 v22, v22, v16
    v_sub_f32 v20, v20, v16
    v_mul_f32 v22, s57, v22
    v_mul_f32 v20, s57, v20
    v_exp_f32 v22, v22
    v_exp_f32 v20, v20
    v_mul_f32 v22, v22, v23
    s_nop 1
    v_add_f32_dpp v22, v22, v22 row_ror:4 row_mask:0xf bank_mask:0xf
    s_nop 1
    v_add_f32_dpp v22, v22, v22 row_ror:8 row_mask:0xf bank_mask:0xf
    v_rcp_f32 v22, v22
    s_nop 0
    v_mul_f32 v20, v20, v22
    s_nop 0
    v_readfirstlane_b32 s60, v20
    s_mov_b64 exec, -1
    s_nop 0
    v_mul_f32 v24, s60, v24
    v_mul_f32 v26, s60, v26
    v_mul_f32 v28, s60, v28
    v_mul_f32 v30, s60, v30
    s_mov_b32 s60, 200000
    v_mov_b32 v16, 1343744
L_pi_229:
    buffer_load_dword v20, v16, s[40:43], 0 offen sc1
    s_waitcnt vmcnt(0)
    v_readfirstlane_b32 s26, v20
    s_xor_b32 s26, s26, s63
    s_cmp_lt_u32 s26, 2
    s_cbranch_scc1 L_pid_230
    s_sleep 32
    s_sub_u32 s60, s60, 1
    s_cbranch_scc0 L_pi_229
L_pid_230:
    s_mul_i32 s26, s26, 0x4446
    s_xor_b32 s27, s27, s26
    v_mov_b32 v16, 0
    v_mov_b32 v20, s27
    ds_write_b32 v16, v20 offset:384
    v_lshlrev_b32 v17, 3, v0
    s_waitcnt lgkmcnt(0)
L_w4_215:
    s_branch L_pg_232
.p2align 12,,800
L_pg_232:
    s_barrier
    s_mul_i32 s10, s3, 20480
    s_add_u32 m0, s10, 15872
    s_nop 0
    buffer_load_dwordx4 v5, s[48:51], s15 offen sc1 lds
    s_add_u32 m0, m0, 1024
    s_add_u32 s15, s15, 3456
    buffer_load_dwordx4 v5, s[48:51], s15 offen sc1 lds
    s_add_u32 m0, m0, 1024
    s_add_u32 s15, s15, 107136
    buffer_load_dwordx4 v5, s[48:51], s15 offen sc1 lds
    s_add_u32 m0, m0, 1024
    s_add_u32 s15, s15, 3456
    buffer_load_dwordx4 v5, s[48:51], s15 offen sc1 lds
    v_and_b32 v16, 1, v0
    v_lshlrev_b32 v16, 2, v16
    v_lshrrev_b32 v16, v16, s27
    v_bfe_u32 v19, v16, 10, 1
    v_bfe_u32 v16, v16, 2, 1
    v_lshl_add_u32 v10, v19, 13, v12
    v_lshl_add_u32 v12, v16, 13, v12
    s_cmp_eq_u32 s3, 0
    s_cbranch_scc0 L_nw4_233
    s_bitcmp1_b32 s27, 0
    s_barrier
    ds_read2st64_b64 v[32:35], v17 offset0:1 offset1:2
    ds_read2st64_b64 v[36:39], v17 offset0:3 offset1:4
    s_waitcnt lgkmcnt(1)
    v_pk_mul_f32 v[22:23], v[32:33], v[24:25] op_sel_hi:[1,0]
    v_pk_fma_f32 v[22:23], v[34:35], v[26:27], v[22:23] op_sel_hi:[1,0,1]
    s_waitcnt lgkmcnt(0)
    v_pk_fma_f32 v[22:23], v[36:37], v[28:29], v[22:23] op_sel_hi:[1,0,1]
    v_pk_fma_f32 v[22:23], v[38:39], v[30:31], v[22:23] op_sel_hi:[1,0,1]
    v_cvt_pk_bf16_f32 v22, v22, v23
    s_cbranch_scc0 L_slow_231
    buffer_store_dword v22, v1, s[40:43], 0 offen
L_e_216:
    s_barrier
    s_add_u32 m0, m0, 1024
    s_add_u32 s15, s15, 107136
    buffer_load_dwordx4 v5, s[48:51], s15 offen sc1 lds
    s_add_u32 m0, m0, 1024
    s_add_u32 s15, s15, 3456
    buffer_load_dwordx4 v5, s[48:51], s15 offen sc1 lds
    s_add_u32 m0, m0, 1024
    s_add_u32 s15, s15, 107136
    buffer_load_dwordx4 v5, s[48:51], s15 offen sc1 lds
    s_add_u32 m0, m0, 1024
    s_add_u32 s15, s15, 3456
    buffer_load_dwordx4 v5, s[48:51], s15 offen sc1 lds
    s_waitcnt vmcnt(6)
    ds_read_b64_tr_b16 v[64:65], v15 offset:0
    ds_read_b64_tr_b16 v[66:67], v15 offset:256
    ds_read_b64_tr_b16 v[72:73], v15 offset:32
    ds_read_b64_tr_b16 v[74:75], v15 offset:288
    s_add_u32 m0, m0, 1024
    s_add_u32 s15, s15, 107136
    buffer_load_dwordx4 v5, s[48:51], s15 offen sc1 lds
    s_add_u32 m0, m0, 1024
    s_add_u32 s15, s15, 3456
    buffer_load_dwordx4 v5, s[48:51], s15 offen sc1 lds
    s_waitcnt vmcnt(6)
    ds_read_b64_tr_b16 v[68:69], v15 offset:2048
    ds_read_b64_tr_b16 v[70:71], v15 offset:2304
    ds_read_b64_tr_b16 v[76:77], v15 offset:2080
    ds_read_b64_tr_b16 v[78:79], v15 offset:2336
    s_waitcnt lgkmcnt(4)
    v_mfma_f32_16x16x32_bf16 v[24:27], v[40:43], v[64:67], 0
    v_mfma_f32_16x16x32_bf16 v[28:31], v[40:43], v[72:75], 0
    s_add_u32 m0, m0, 1024
    s_sub_u32 s15, s15, 445824
    buffer_load_dwordx4 v5, s[52:55], s15 offen sc1 lds
    s_add_u32 m0, m0, 1024
    s_add_u32 s15, s15, 3456
    buffer_load_dwordx4 v5, s[52:55], s15 offen sc1 lds
    s_waitcnt vmcnt(6)
    ds_read_b64_tr_b16 v[96:97], v15 offset:4096
    ds_read_b64_tr_b16 v[98:99], v15 offset:4352
    ds_read_b64_tr_b16 v[104:105], v15 offset:4128
    ds_read_b64_tr_b16 v[106:107], v15 offset:4384
    s_waitcnt lgkmcnt(4)
    v_mfma_f32_16x16x32_bf16 v[24:27], v[40:43], v[68:71], v[24:27]
    v_mfma_f32_16x16x32_bf16 v[28:31], v[40:43], v[76:79], v[28:31]
    s_add_u32 m0, m0, 1024
    s_add_u32 s15, s15, 107136
    buffer_load_dwordx4 v5, s[52:55], s15 offen sc1 lds
    s_add_u32 m0, m0, 1024
    s_add_u32 s15, s15, 3456
    buffer_load_dwordx4 v5, s[52:55], s15 offen sc1 lds
    s_waitcnt vmcnt(6)
    ds_read_b64_tr_b16 v[100:101], v15 offset:6144
    ds_read_b64_tr_b16 v[102:103], v15 offset:6400
    ds_read_b64_tr_b16 v[108:109], v15 offset:6176
    ds_read_b64_tr_b16 v[110:111], v15 offset:6432
    s_waitcnt lgkmcnt(4)
    v_mfma_f32_16x16x32_bf16 v[24:27], v[40:43], v[96:99], v[24:27]
    v_mfma_f32_16x16x32_bf16 v[28:31], v[40:43], v[104:107], v[28:31]
    s_add_u32 m0, m0, 1024
    s_add_u32 s15, s15, 107136
    buffer_load_dwordx4 v5, s[52:55], s15 offen sc1 lds
    s_add_u32 m0, m0, 1024
    s_add_u32 s15, s15, 3456
    buffer_load_dwordx4 v5, s[52:55], s15 offen sc1 lds
    s_waitcnt vmcnt(6)
    ds_read_b64_tr_b16 v[128:129], v15 offset:8192
    ds_read_b64_tr_b16 v[130:131], v15 offset:8448
    ds_read_b64_tr_b16 v[132:133], v15 offset:8224
    ds_read_b64_tr_b16 v[134:135], v15 offset:8480
    s_waitcnt lgkmcnt(4)
    v_mfma_f32_16x16x32_bf16 v[24:27], v[40:43], v[100:103], v[24:27]
    v_mfma_f32_16x16x32_bf16 v[28:31], v[40:43], v[108:111], v[28:31]
    s_add_u32 m0, m0, 1024
    s_add_u32 s15, s15, 107136
    buffer_load_dwordx4 v5, s[52:55], s15 offen sc1 lds
    s_add_u32 m0, m0, 1024
    s_add_u32 s15, s15, 3456
    buffer_load_dwordx4 v5, s[52:55], s15 offen sc1 lds
    s_branch L_pg_234
.p2align 12,,1600
L_pg_234:
    s_waitcnt vmcnt(6)
    ds_read_b64_tr_b16 v[80:81], v15 offset:10240
    ds_read_b64_tr_b16 v[82:83], v15 offset:10496
    ds_read_b64_tr_b16 v[88:89], v15 offset:10272
    ds_read_b64_tr_b16 v[90:91], v15 offset:10528
    s_waitcnt lgkmcnt(4)
    v_mfma_f32_16x16x32_bf16 v[24:27], v[40:43], v[128:131], v[24:27]
    v_mfma_f32_16x16x32_bf16 v[28:31], v[40:43], v[132:135], v[28:31]
    s_add_u32 m0, m0, 1024
    s_add_u32 s15, s15, 107136
    buffer_load_dwordx4 v5, s[52:55], s15 offen sc1 lds
    s_add_u32 m0, m0, 1024
    s_add_u32 s15, s15, 3456
    buffer_load_dwordx4 v5, s[52:55], s15 offen sc1 lds
    s_waitcnt vmcnt(6)
    ds_read_b64_tr_b16 v[84:85], v15 offset:12288
    ds_read_b64_tr_b16 v[86:87], v15 offset:12544
    ds_read_b64_tr_b16 v[92:93], v15 offset:12320
    ds_read_b64_tr_b16 v[94:95], v15 offset:12576
    s_waitcnt lgkmcnt(4)
    v_mfma_f32_16x16x32_bf16 v[32:35], v[40:43], v[80:83], 0
    v_mfma_f32_16x16x32_bf16 v[36:39], v[40:43], v[88:91], 0
    s_waitcnt vmcnt(4)
    s_barrier
    ds_read_b64_tr_b16 v[112:113], v15 offset:14336
    ds_read_b64_tr_b16 v[114:115], v15 offset:14592
    ds_read_b64_tr_b16 v[120:121], v15 offset:14368
    ds_read_b64_tr_b16 v[122:123], v15 offset:14624
    s_waitcnt lgkmcnt(4)
    v_mfma_f32_16x16x32_bf16 v[32:35], v[40:43], v[84:87], v[32:35]
    v_mfma_f32_16x16x32_bf16 v[36:39], v[40:43], v[92:95], v[36:39]
    s_waitcnt vmcnt(2)
    ds_read_b64_tr_b16 v[116:117], v15 offset:16384
    ds_read_b64_tr_b16 v[118:119], v15 offset:16640
    ds_read_b64_tr_b16 v[124:125], v15 offset:16416
    ds_read_b64_tr_b16 v[126:127], v15 offset:16672
    s_waitcnt lgkmcnt(4)
    v_mfma_f32_16x16x32_bf16 v[32:35], v[40:43], v[112:115], v[32:35]
    v_mfma_f32_16x16x32_bf16 v[36:39], v[40:43], v[120:123], v[36:39]
    s_waitcnt vmcnt(0)
    buffer_load_dwordx4 v[60:63], v6, s[40:43], s11 offen sc1
    ds_read_b64_tr_b16 v[136:137], v15 offset:18432
    ds_read_b64_tr_b16 v[138:139], v15 offset:18688
    ds_read_b64_tr_b16 v[140:141], v15 offset:18464
    ds_read_b64_tr_b16 v[142:143], v15 offset:18720
    s_waitcnt lgkmcnt(4)
    v_mfma_f32_16x16x32_bf16 v[32:35], v[40:43], v[116:119], v[32:35]
    v_mfma_f32_16x16x32_bf16 v[36:39], v[40:43], v[124:127], v[36:39]
    s_waitcnt lgkmcnt(0)
    v_mfma_f32_16x16x32_bf16 v[32:35], v[40:43], v[136:139], v[32:35]
    v_mfma_f32_16x16x32_bf16 v[36:39], v[40:43], v[140:143], v[36:39]
    s_mov_b64 exec, 0xffff
    ds_write2_b32 v8, v24, v25 offset0:0 offset1:64
    ds_write2_b32 v8, v28, v29 offset0:32 offset1:96
    s_nop 3
    ds_write2_b32 v9, v32, v33 offset0:0 offset1:64
    ds_write2_b32 v9, v36, v37 offset0:32 offset1:96
    s_mov_b64 exec, -1
    s_mov_b32 s60, 200000
L_poll_235:
    buffer_load_dwordx4 v[40:43], v6, s[40:43], s11 offen sc1
    s_sub_u32 s60, s60, 1
    s_cbranch_scc1 L_end
    s_waitcnt vmcnt(1)
    v_mfma_f32_16x16x32_bf16 v[24:27], v[60:63], v[128:131], 0
    v_mov_b32_dpp v44, v60 row_shl:4 row_mask:0xf bank_mask:0xf bound_ctrl:1
    v_mov_b32_dpp v45, v61 row_shl:4 row_mask:0xf bank_mask:0xf bound_ctrl:1
    v_mfma_f32_16x16x32_bf16 v[28:31], v[60:63], v[132:135], 0
    v_mov_b32_dpp v46, v62 row_shl:4 row_mask:0xf bank_mask:0xf bound_ctrl:1
    v_mov_b32_dpp v47, v63 row_shl:4 row_mask:0xf bank_mask:0xf bound_ctrl:1
    v_mfma_f32_16x16x32_bf16 v[32:35], v[60:63], v[136:139], 0
    v_max_u32 v16, v60, v61
    v_max3_u32 v16, v16, v62, v63
    v_mfma_f32_16x16x32_bf16 v[36:39], v[60:63], v[140:143], 0
    v_cmp_eq_u32 vcc, -1, v16
    s_cbranch_vccz L_gotA_236
    buffer_load_dwordx4 v[60:63], v6, s[40:43], s11 offen sc1
    s_waitcnt vmcnt(1)
    v_mfma_f32_16x16x32_bf16 v[24:27], v[40:43], v[128:131], 0
    v_mov_b32_dpp v44, v40 row_shl:4 row_mask:0xf bank_mask:0xf bound_ctrl:1
    v_mov_b32_dpp v45, v41 row_shl:4 row_mask:0xf bank_mask:0xf bound_ctrl:1
    v_mfma_f32_16x16x32_bf16 v[28:31], v[40:43], v[132:135], 0
    v_mov_b32_dpp v46, v42 row_shl:4 row_mask:0xf bank_mask:0xf bound_ctrl:1
    v_mov_b32_dpp v47, v43 row_shl:4 row_mask:0xf bank_mask:0xf bound_ctrl:1
    v_mfma_f32_16x16x32_bf16 v[32:35], v[40:43], v[136:139], 0
    v_max_u32 v16, v40, v41
    v_max3_u32 v16, v16, v42, v43
    v_mfma_f32_16x16x32_bf16 v[36:39], v[40:43], v[140:143], 0
    v_cmp_eq_u32 vcc, -1, v16
    s_cbranch_vccnz L_poll_235
    v_smfmac_f32_16x16x64_bf16 v[24:27], v[44:47], v[64:71], v59
    v_mov_b32_dpp v48, v40 row_shl:8 row_mask:0xf bank_mask:0xf bound_ctrl:1
    v_mov_b32_dpp v49, v41 row_shl:8 row_mask:0xf bank_mask:0xf bound_ctrl:1
    v_smfmac_f32_16x16x64_bf16 v[28:31], v[44:47], v[72:79], v59
    v_mov_b32_dpp v50, v42 row_shl:8 row_mask:0xf bank_mask:0xf bound_ctrl:1
    v_mov_b32_dpp v51, v43 row_shl:8 row_mask:0xf bank_mask:0xf bound_ctrl:1
    s_branch L_got_237
L_gotA_236:
    v_smfmac_f32_16x16x64_bf16 v[24:27], v[44:47], v[64:71], v59
    v_mov_b32_dpp v48, v60 row_shl:8 row_mask:0xf bank_mask:0xf bound_ctrl:1
    v_mov_b32_dpp v49, v61 row_shl:8 row_mask:0xf bank_mask:0xf bound_ctrl:1
    v_smfmac_f32_16x16x64_bf16 v[28:31], v[44:47], v[72:79], v59
    v_mov_b32_dpp v50, v62 row_shl:8 row_mask:0xf bank_mask:0xf bound_ctrl:1
    v_mov_b32_dpp v51, v63 row_shl:8 row_mask:0xf bank_mask:0xf bound_ctrl:1
L_got_237:
    v_smfmac_f32_16x16x64_bf16 v[32:35], v[44:47], v[80:87], v59
    v_smfmac_f32_16x16x64_bf16 v[36:39], v[44:47], v[88:95], v59
    v_smfmac_f32_16x16x64_bf16 v[24:27], v[48:51], v[96:103], v59
    v_smfmac_f32_16x16x64_bf16 v[28:31], v[48:51], v[104:111], v59
    v_smfmac_f32_16x16x64_bf16 v[32:35], v[48:51], v[112:119], v59
    v_smfmac_f32_16x16x64_bf16 v[36:39], v[48:51], v[120:127], v59
    s_nop 4
    v_pk_add_f32 v[24:25], v[24:25], v[26:27]
    v_pk_add_f32 v[28:29], v[28:29], v[30:31]
    v_pk_add_f32 v[32:33], v[32:33], v[34:35]
    v_pk_add_f32 v[36:37], v[36:37], v[38:39]
    s_mov_b64 exec, 0xffff
    ds_write2_b32 v11, v24, v25 offset0:0 offset1:64
    ds_write2_b32 v11, v28, v29 offset0:32 offset1:96
    ds_write2_b32 v14, v32, v33 offset0:0 offset1:64
    ds_write2_b32 v14, v36, v37 offset0:32 offset1:96
    s_mov_b64 exec, -1
    s_cmp_eq_u32 s3, 0
    s_waitcnt lgkmcnt(0)
    s_barrier
    s_cbranch_scc0 L_gend
    ds_read2st64_b64 v[32:35], v13 offset0:11 offset1:12
    ds_read2st64_b64 v[36:39], v13 offset0:13 offset1:14
    ds_read2st64_b64 v[24:27], v13 offset0:7 offset1:8
    ds_read2st64_b64 v[28:31], v13 offset0:9 offset1:10
    ds_read_b64 v[20:21], v7 offset:320
    s_waitcnt lgkmcnt(3)
    v_pk_add_f32 v[32:33], v[32:33], v[34:35]
    v_pk_add_f32 v[36:37], v[36:37], v[38:39]
    v_pk_add_f32 v[32:33], v[32:33], v[36:37]
    s_waitcnt lgkmcnt(0)
    v_pk_add_f32 v[24:25], v[24:25], v[26:27]
    v_pk_add_f32 v[28:29], v[28:29], v[30:31]
    v_pk_fma_f32 v[24:25], v[32:33], v[20:21], v[24:25] op_sel_hi:[1,0,1] neg_lo:[1,0,0] neg_hi:[1,0,0]
    v_pk_add_f32 v[24:25], v[24:25], v[28:29]
    v_pk_mul_f32 v[24:25], v[24:25], v[20:21] op_sel:[0,1] op_sel_hi:[1,1]
    v_mul_f32 v16, v24, v24
    v_fmamk_f32 v16, v16, 0xbdd2d3e8, v18
    v_mul_f32 v16, v16, v24
    v_exp_f32 v16, v16
    v_mul_f32 v25, v24, v25
    v_add_f32 v16, 1.0, v16
    v_rcp_f32 v16, v16
    s_nop 0
    v_mul_f32 v16, v16, v25
    s_nop 1
    v_mov_b32_dpp v17, v16 quad_perm:[1,1,3,3] row_mask:0xf bank_mask:0xf
    v_mov_b32_dpp v18, v16 quad_perm:[0,0,2,2] row_mask:0xf bank_mask:0xf
    v_cvt_pk_bf16_f32 v16, v18, v17
    buffer_store_dword v16, v12, s[40:43], 0 offen sc1
    buffer_store_dword v16, v10, s[40:43], s12 offen sc1
L_gend:
    s_lshl2_add_u32 s10, s9, s3
    s_cmp_eq_u32 s10, 1
    s_cbranch_scc0 L_gend2
    s_mov_b64 exec, 1
    v_mov_b32 v17, 0
    v_mov_b32 v18, s63
    buffer_store_dword v18, v17, s[40:43], 0 offen sc1
L_gend2:
    s_endpgm
L_roleD:
    s_mov_b32 s48, s32
    s_and_b32 s49, s33, 0xffff
    s_mov_b32 s50, 2211840
    s_mov_b32 s51, 0x20000
    s_mov_b32 s52, s34
    s_and_b32 s53, s35, 0xffff
    s_mov_b32 s54, 2560
    s_mov_b32 s55, 0x20000
    s_mul_i32 s10, s3, 655360
    s_lshl_b32 s11, s9, 5
    s_add_u32 s10, s10, s11
    v_lshrrev_b32 v5, 5, v0
    v_lshrrev_b32 v6, 3, v3
    v_lshl_add_u32 v5, v5, 1, v6
    v_and_b32 v6, 1, v4
    v_lshl_add_u32 v5, v5, 3, v6
    v_mul_u32_u24 v5, 5120, v5
    v_and_b32 v6, 7, v3
    v_lshl_add_u32 v5, v6, 2, v5
    v_add_u32 v5, s10, v5
    v_add_u32 v57, 163840, v5
    v_add_u32 v19, 327680, v5
    v_add_u32 v58, 491520, v5
    v_bfe_u32 v18, v0, 0, 1
    v_mul_u32_u24 v18, 0xaaaa, v18
    v_add_u32 v18, 0x4444, v18
    s_and_b32 s25, s9, 3
    s_lshl_b32 s11, s9, 5
    v_and_b32 v6, 3, v0
    v_bfe_u32 v7, v0, 4, 1
    v_lshl_add_u32 v6, v7, 2, v6
    v_bfe_u32 v7, v0, 2, 2
    v_lshrrev_b32 v8, 5, v0
    v_mul_u32_u24 v9, 1280, v8
    v_lshl_add_u32 v9, v6, 2, v9
    v_add_u32 v9, s11, v9
    s_and_b32 s13, s2, 7
    s_lshl_b32 s13, s13, 13
    s_add_u32 s13, s13, 1773568
    s_lshr_b32 s10, s9, 1
    s_lshl_b32 s10, s10, 6
    s_add_u32 s13, s13, s10
    s_and_b32 s10, s9, 1
    s_lshl_b32 s10, s10, 4
    s_add_u32 s13, s13, s10
    v_mul_u32_u24 v10, 1280, v8
    v_lshrrev_b32 v11, 1, v6
    v_lshl_add_u32 v10, v11, 2, v10
    v_and_b32 v11, 1, v6
    v_lshlrev_b32 v11, 4, v11
    v_lshlrev_b32 v13, 8, v7
    v_lshl_add_u32 v13, v8, 6, v13
    v_lshl_add_u32 v13, v6, 3, v13
    v_add_u32 v13, 3584, v13
    v_add_u32 v6, s25, v0
    v_and_b32 v6, 3, v6
    v_and_or_b32 v6, v0, 60, v6
    s_lshl_b32 s10, s3, 11
    v_lshl_add_u32 v6, v6, 4, s10
    v_add_u32 v7, 1024, v6
    v_min_u32 v6, 6896, v6
    v_min_u32 v7, 6896, v7
    s_and_b32 s14, s2, 3
    s_lshl_b32 s14, s14, 14
    s_add_u32 s14, s14, 1703936
    s_lshl_b32 s10, s3, 8
    s_add_u32 s10, s10, 3584
    v_and_b32 v12, 7, v0
    v_lshlrev_b32 v12, 3, v12
    v_lshl_add_u32 v12, v4, 6, v12
    v_add_u32 v12, s10, v12
    s_cmp_ge_u32 s3, 2
    s_cbranch_scc0 L_noctl_244
    s_lshr_b32 s18, s2, 3
    s_mul_i32 s19, s18, 205
    s_lshr_b32 s19, s19, 10
    s_mov_b32 s23, 1000
    s_lshl_b32 s17, s19, 12
    s_add_u32 s20, s38, 1048576
    s_addc_u32 s21, s39, 0
    s_and_b32 s24, s2, 7
    s_cmp_ge_u32 s24, 3
    s_cselect_b32 s27, 0, 0
    s_and_b32 s24, s2, 7
    s_lshl_b32 s24, s24, 12
    s_add_u32 s24, s24, 1312768
    s_lshl_b32 s18, s18, 2
    s_lshl_b32 s19, s19, 2
    s_add_u32 s19, s19, 128
    v_mov_b32 v21, s18
    v_mov_b32 v22, s19
    v_mov_b32 v16, 0
    v_lshlrev_b32 v17, 3, v0
    v_lshlrev_b32 v23, 2, v0
    s_sub_u32 s16, s3, 1
    v_mov_b32 v25, 0x7fffffff
    v_writelane_b32 v25, 60, 0
    s_mov_b32 s19, 72
    v_writelane_b32 v25, s19, 1
    s_mov_b32 s19, 66
    v_writelane_b32 v25, s19, 2
    s_mov_b32 s19, 78
    v_writelane_b32 v25, s19, 3
    v_writelane_b32 v25, 63, 4
    s_mov_b32 s19, 75
    v_writelane_b32 v25, s19, 5
    s_mov_b32 s19, 69
    v_writelane_b32 v25, s19, 6
    s_mov_b32 s19, 81
    v_writelane_b32 v25, s19, 7
    s_mov_b32 s19, 83
    v_writelane_b32 v25, s19, 8
    s_mov_b32 s19, 91
    v_writelane_b32 v25, s19, 9
    s_mov_b32 s19, 87
    v_writelane_b32 v25, s19, 10
    s_mov_b32 s19, 95
    v_writelane_b32 v25, s19, 11
    s_mov_b32 s19, 85
    v_writelane_b32 v25, s19, 12
    s_mov_b32 s19, 93
    v_writelane_b32 v25, s19, 13
    s_mov_b32 s19, 89
    v_writelane_b32 v25, s19, 14
    s_mov_b32 s19, 97
    v_writelane_b32 v25, s19, 15
    s_mov_b32 s19, 99
    v_writelane_b32 v25, s19, 16
    s_mov_b32 s19, 107
    v_writelane_b32 v25, s19, 17
    s_mov_b32 s19, 103
    v_writelane_b32 v25, s19, 18
    s_mov_b32 s19, 111
    v_writelane_b32 v25, s19, 19
    s_mov_b32 s19, 101
    v_writelane_b32 v25, s19, 20
    s_mov_b32 s19, 109
    v_writelane_b32 v25, s19, 21
    s_mov_b32 s19, 105
    v_writelane_b32 v25, s19, 22
    s_mov_b32 s19, 113
    v_writelane_b32 v25, s19, 23
L_cn_247:
    s_mov_b32 s60, 200000
L_cw_245:
    ds_read_b32 v20, v16 offset:352
    s_waitcnt lgkmcnt(0)
    v_readfirstlane_b32 s18, v20
    s_add_u32 s18, s18, 2
    s_lshr_b32 s18, s18, 2
    s_cmp_ge_u32 s18, s16
    s_cbranch_scc1 L_cg_246
    s_sleep 1
    s_sub_u32 s60, s60, 1
    s_cbranch_scc0 L_cw_245
L_cg_246:
    s_add_u32 s18, s16, s63
    v_mov_b32 v20, s18
    s_mov_b64 exec, 1
    buffer_store_dword v20, v21, s[40:43], s24 offen
    s_mov_b64 exec, -1
    s_cmp_eq_u32 s16, 24
    s_cbranch_scc1 L_noctl_244
    buffer_load_dword v24, v23, s[40:43], s24 offen sc1
    s_cmp_eq_u32 s16, s23
    s_cbranch_scc0 L_cr_248
    s_mov_b32 s18, 1
    s_atomic_add s18, s[20:21], s17 glc
    s_add_u32 s17, s17, 16384
    s_add_u32 s23, s23, 2
    s_cmp_gt_u32 s23, 23
    s_cselect_b32 s23, 1000, s23
    s_waitcnt lgkmcnt(0)
    s_lshl_b32 s18, s18, 1
    s_add_u32 s18, s18, s63
    v_mov_b32 v20, s18
    s_mov_b64 exec, 1
    buffer_store_dword v20, v22, s[40:43], s24 offen
    s_mov_b64 exec, -1
L_cr_248:
    s_waitcnt vmcnt(0)
    v_subrev_u32 v24, s63, v24
    v_lshrrev_b32 v20, 5, v0
    v_mul_u32_u24 v20, 7, v20
    v_cmp_gt_u32 vcc, 64, v24
    s_nop 1
    v_cndmask_b32 v24, v20, v24, vcc
    s_nop 1
    v_add_u32_dpp v24, v24, v24 quad_perm:[1,0,3,2] row_mask:0xf bank_mask:0xf
    s_nop 1
    v_add_u32_dpp v24, v24, v24 quad_perm:[2,3,0,1] row_mask:0xf bank_mask:0xf
    s_nop 1
    v_add_u32_dpp v24, v24, v24 row_half_mirror row_mask:0xf bank_mask:0xf
    s_nop 1
    v_add_u32_dpp v24, v24, v24 row_mirror row_mask:0xf bank_mask:0xf
    s_nop 0
    v_readlane_b32 s18, v24, 0
    v_readlane_b32 s19, v24, 16
    v_readlane_b32 s26, v24, 32
    s_add_u32 s18, s18, s19
    s_mul_i32 s26, s26, 3
    s_lshr_b32 s26, s26, 2
    s_add_u32 s18, s18, s26
    s_lshl_b32 s19, s16, 5
    s_sub_u32 s18, s18, s19
    s_add_u32 s18, s18, s27
    s_sub_u32 s18, s18, 6
    v_cmp_ge_i32 vcc, s18, v25
    s_add_u32 s18, s18, 4
    s_nop 0
    v_mov_b32 v28, vcc_lo
    v_cmp_ge_i32 vcc, s18, v25
    s_add_u32 s18, s18, 4
    s_nop 0
    v_mov_b32 v29, vcc_lo
    v_cmp_ge_i32 vcc, s18, v25
    s_add_u32 s18, s18, 4
    s_nop 0
    v_mov_b32 v30, vcc_lo
    v_cmp_ge_i32 vcc, s18, v25
    s_add_u32 s18, s18, 4
    s_nop 0
    v_mov_b32 v31, vcc_lo
    s_mov_b64 exec, 1
    ds_write_b128 v16, v[28:31] offset:368
    s_mov_b64 exec, -1
    s_add_u32 s16, s16, 2
    s_cmp_le_u32 s16, 24
    s_cbranch_scc1 L_cn_247
L_noctl_244:
    s_cmp_eq_u32 s3, 0
    s_cbranch_scc0 L_w4_242
    s_mov_b32 s60, 200000
    v_lshrrev_b32 v16, 1, v0
    v_lshlrev_b32 v16, 12, v16
    v_and_b32 v17, 1, v0
    v_lshl_add_u32 v16, v17, 4, v16
    v_add_u32 v16, 1048704, v16
L_chk_249:
    buffer_load_dwordx4 v[20:23], v16, s[40:43], 0 offen sc1
    s_waitcnt vmcnt(0)
    v_xor_b32 v20, s63, v20
    v_xor_b32 v21, s63, v21
    v_xor_b32 v22, s63, v22
    v_xor_b32 v23, s63, v23
    v_or3_b32 v24, v20, v21, v22
    v_or_b32 v24, v24, v23
    v_cmp_lt_u32 vcc, 15, v24
    s_cbranch_vccz L_chkd_250
    s_sleep 32
    s_sub_u32 s60, s60, 1
    s_cbranch_scc0 L_chk_249
L_chkd_250:
    v_lshl_or_b32 v20, v21, 4, v20
    v_lshl_or_b32 v22, v23, 4, v22
    v_lshl_or_b32 v20, v22, 8, v20
    s_nop 0
    v_readlane_b32 s26, v20, 0
    v_readlane_b32 s27, v20, 1
    v_cmp_eq_u32 vcc, 0, v17
    v_mov_b32 v21, s26
    v_mov_b32 v22, s27
    v_cndmask_b32 v21, v22, v21, vcc
    v_cmp_ne_u32 vcc, v20, v21
    s_cmp_eq_u64 vcc, 0
    s_cselect_b32 s27, 1, 0
    s_and_b32 s26, s26, 0x4444
    s_or_b32 s27, s27, s26
    s_bitcmp1_b32 s27, 0
    s_cbranch_scc1 L_noq_251
    buffer_store_dwordx4 v[48:51], v56, s[40:43], 0 offen sc1
L_noq_251:
    s_getreg_b32 s26, hwreg(HW_REG_XCC_ID, 2, 1)
    s_lshl_b32 s26, s26, 1
    s_or_b32 s27, s27, s26
    s_mov_b32 s60, 200000
    v_mov_b32 v16, 0
L_ml_240:
    ds_read_b128 v[24:27], v16 offset:256
    ds_read_b128 v[28:31], v16 offset:272
    s_waitcnt lgkmcnt(0)
    v_max3_u32 v20, v25, v27, v29
    v_max_u32 v20, v20, v31
    v_cmp_eq_u32 vcc, -1, v20
    s_cbranch_vccz L_mld_241
    s_sleep 16
    s_sub_u32 s60, s60, 1
    s_cbranch_scc0 L_ml_240
L_mld_241:
    v_max3_f32 v20, v24, v26, v28
    v_max_f32 v20, v20, v30
    v_sub_f32 v24, v24, v20
    v_sub_f32 v26, v26, v20
    v_sub_f32 v28, v28, v20
    v_sub_f32 v30, v30, v20
    v_mul_f32 v24, s57, v24
    v_mul_f32 v26, s57, v26
    v_mul_f32 v28, s57, v28
    v_mul_f32 v30, s57, v30
    v_exp_f32 v24, v24
    v_exp_f32 v26, v26
    v_exp_f32 v28, v28
    v_exp_f32 v30, v30
    v_mul_f32 v21, v24, v25
    v_fmac_f32 v21, v26, v27
    v_fmac_f32 v21, v28, v29
    v_fmac_f32 v21, v30, v31
    s_mov_b64 exec, 1
    s_bitcmp1_b32 s27, 0
    s_cbranch_scc0 L_mls_252
    buffer_store_dwordx2 v[20:21], v2, s[40:43], 0 offen
L_mlz_253:
    s_mov_b64 exec, -1
    v_and_b32 v17, 0xffffffe0, v2
    v_bfe_u32 v16, v0, 2, 2
    v_lshl_add_u32 v17, v16, 3, v17
    s_mov_b64 exec, 0xffff
    s_mov_b32 s60, 200000
L_poll_254:
    buffer_load_dwordx2 v[22:23], v17, s[40:43], 0 offen sc1
    s_waitcnt vmcnt(0)
    v_max_u32 v16, v22, v23
    v_cmp_eq_u32 vcc, -1, v16
    s_cbranch_vccz L_got_255
    s_sleep 16
    s_sub_u32 s60, s60, 1
    s_cbranch_scc0 L_poll_254
L_got_255:
    v_max_f32_dpp v16, v22, v22 row_ror:4 row_mask:0xf bank_mask:0xf
    s_nop 1
    v_max_f32_dpp v16, v16, v16 row_ror:8 row_mask:0xf bank_mask:0xf
    v_sub_f32 v22, v22, v16
    v_sub_f32 v20, v20, v16
    v_mul_f32 v22, s57, v22
    v_mul_f32 v20, s57, v20
    v_exp_f32 v22, v22
    v_exp_f32 v20, v20
    v_mul_f32 v22, v22, v23
    s_nop 1
    v_add_f32_dpp v22, v22, v22 row_ror:4 row_mask:0xf bank_mask:0xf
    s_nop 1
    v_add_f32_dpp v22, v22, v22 row_ror:8 row_mask:0xf bank_mask:0xf
    v_rcp_f32 v22, v22
    s_nop 0
    v_mul_f32 v20, v20, v22
    s_nop 0
    v_readfirstlane_b32 s60, v20
    s_mov_b64 exec, -1
    s_nop 0
    v_mul_f32 v24, s60, v24
    v_mul_f32 v26, s60, v26
    v_mul_f32 v28, s60, v28
    v_mul_f32 v30, s60, v30
    s_mov_b32 s60, 200000
    v_mov_b32 v16, 1343744
L_pi_256:
    buffer_load_dword v20, v16, s[40:43], 0 offen sc1
    s_waitcnt vmcnt(0)
    v_readfirstlane_b32 s26, v20
    s_xor_b32 s26, s26, s63
    s_cmp_lt_u32 s26, 2
    s_cbranch_scc1 L_pid_257
    s_sleep 32
    s_sub_u32 s60, s60, 1
    s_cbranch_scc0 L_pi_256
L_pid_257:
    s_mul_i32 s26, s26, 0x4446
    s_xor_b32 s27, s27, s26
    v_mov_b32 v16, 0
    v_mov_b32 v20, s27
    ds_write_b32 v16, v20 offset:384
    v_lshlrev_b32 v17, 3, v0
    s_waitcnt lgkmcnt(0)
L_w4_242:
    s_branch L_pg_259
.p2align 12,,800
L_pg_259:
    s_barrier
    s_add_u32 s15, s25, 0
    s_and_b32 s15, s15, 3
    s_mul_i32 s15, s15, 10240
    buffer_load_dword v64, v5, s[48:51], s15 offen offset:0 sc1
    buffer_load_dword v72, v5, s[48:51], s15 offen offset:1280 sc1
    buffer_load_dword v66, v5, s[48:51], s15 offen offset:2560 sc1
    s_cmp_eq_u32 s3, 0
    s_cbranch_scc0 L_nw4_260
    s_bitcmp1_b32 s27, 0
    s_barrier
    ds_read2st64_b64 v[32:35], v17 offset0:1 offset1:2
    ds_read2st64_b64 v[36:39], v17 offset0:3 offset1:4
    s_waitcnt lgkmcnt(1)
    v_pk_mul_f32 v[22:23], v[32:33], v[24:25] op_sel_hi:[1,0]
    v_pk_fma_f32 v[22:23], v[34:35], v[26:27], v[22:23] op_sel_hi:[1,0,1]
    s_waitcnt lgkmcnt(0)
    v_pk_fma_f32 v[22:23], v[36:37], v[28:29], v[22:23] op_sel_hi:[1,0,1]
    v_pk_fma_f32 v[22:23], v[38:39], v[30:31], v[22:23] op_sel_hi:[1,0,1]
    v_cvt_pk_bf16_f32 v22, v22, v23
    s_cbranch_scc0 L_slow_258
    buffer_store_dword v22, v1, s[40:43], 0 offen
L_e_243:
    s_barrier
    buffer_load_dword v74, v5, s[48:51], s15 offen offset:3840 sc1
    buffer_load_dword v68, v57, s[48:51], s15 offen offset:0 sc1
    buffer_load_dword v76, v57, s[48:51], s15 offen offset:1280 sc1
    buffer_load_dword v70, v57, s[48:51], s15 offen offset:2560 sc1
    buffer_load_dword v78, v57, s[48:51], s15 offen offset:3840 sc1
    buffer_load_dword v96, v19, s[48:51], s15 offen offset:0 sc1
    buffer_load_dword v104, v19, s[48:51], s15 offen offset:1280 sc1
    buffer_load_dword v98, v19, s[48:51], s15 offen offset:2560 sc1
    buffer_load_dword v106, v19, s[48:51], s15 offen offset:3840 sc1
    buffer_load_dword v100, v58, s[48:51], s15 offen offset:0 sc1
    buffer_load_dword v108, v58, s[48:51], s15 offen offset:1280 sc1
    buffer_load_dword v102, v58, s[48:51], s15 offen offset:2560 sc1
    buffer_load_dword v110, v58, s[48:51], s15 offen offset:3840 sc1
    s_add_u32 s15, s25, 1
    s_and_b32 s15, s15, 3
    s_mul_i32 s15, s15, 10240
    buffer_load_dword v65, v5, s[48:51], s15 offen offset:0 sc1
    buffer_load_dword v73, v5, s[48:51], s15 offen offset:1280 sc1
    buffer_load_dword v67, v5, s[48:51], s15 offen offset:2560 sc1
    buffer_load_dword v75, v5, s[48:51], s15 offen offset:3840 sc1
    buffer_load_dword v69, v57, s[48:51], s15 offen offset:0 sc1
    buffer_load_dword v77, v57, s[48:51], s15 offen offset:1280 sc1
    buffer_load_dword v71, v57, s[48:51], s15 offen offset:2560 sc1
    buffer_load_dword v79, v57, s[48:51], s15 offen offset:3840 sc1
    buffer_load_dword v97, v19, s[48:51], s15 offen offset:0 sc1
    buffer_load_dword v105, v19, s[48:51], s15 offen offset:1280 sc1
    buffer_load_dword v99, v19, s[48:51], s15 offen offset:2560 sc1
    buffer_load_dword v107, v19, s[48:51], s15 offen offset:3840 sc1
    buffer_load_dword v101, v58, s[48:51], s15 offen offset:0 sc1
    buffer_load_dword v109, v58, s[48:51], s15 offen offset:1280 sc1
    buffer_load_dword v103, v58, s[48:51], s15 offen offset:2560 sc1
    buffer_load_dword v111, v58, s[48:51], s15 offen offset:3840 sc1
    s_add_u32 s15, s25, 2
    s_and_b32 s15, s15, 3
    s_mul_i32 s15, s15, 10240
    buffer_load_dword v80, v5, s[48:51], s15 offen offset:0 sc1
    buffer_load_dword v88, v5, s[48:51], s15 offen offset:1280 sc1
    buffer_load_dword v82, v5, s[48:51], s15 offen offset:2560 sc1
    buffer_load_dword v90, v5, s[48:51], s15 offen offset:3840 sc1
    buffer_load_dword v84, v57, s[48:51], s15 offen offset:0 sc1
    buffer_load_dword v92, v57, s[48:51], s15 offen offset:1280 sc1
    buffer_load_dword v86, v57, s[48:51], s15 offen offset:2560 sc1
    buffer_load_dword v94, v57, s[48:51], s15 offen offset:3840 sc1
    buffer_load_dword v112, v19, s[48:51], s15 offen offset:0 sc1
    buffer_load_dword v120, v19, s[48:51], s15 offen offset:1280 sc1
    buffer_load_dword v114, v19, s[48:51], s15 offen offset:2560 sc1
    buffer_load_dword v122, v19, s[48:51], s15 offen offset:3840 sc1
    buffer_load_dword v116, v58, s[48:51], s15 offen offset:0 sc1
    buffer_load_dword v124, v58, s[48:51], s15 offen offset:1280 sc1
    buffer_load_dword v118, v58, s[48:51], s15 offen offset:2560 sc1
    buffer_load_dword v126, v58, s[48:51], s15 offen offset:3840 sc1
    s_add_u32 s15, s25, 3
    s_and_b32 s15, s15, 3
    s_mul_i32 s15, s15, 10240
    buffer_load_dword v81, v5, s[48:51], s15 offen offset:0 sc1
    buffer_load_dword v89, v5, s[48:51], s15 offen offset:1280 sc1
    buffer_load_dword v83, v5, s[48:51], s15 offen offset:2560 sc1
    buffer_load_dword v91, v5, s[48:51], s15 offen offset:3840 sc1
    buffer_load_dword v85, v57, s[48:51], s15 offen offset:0 sc1
    buffer_load_dword v93, v57, s[48:51], s15 offen offset:1280 sc1
    buffer_load_dword v87, v57, s[48:51], s15 offen offset:2560 sc1
    buffer_load_dword v95, v57, s[48:51], s15 offen offset:3840 sc1
    s_waitcnt vmcnt(48)
    v_perm_b32 v16, v72, v64, s61
    v_perm_b32 v72, v72, v64, s62
    v_mov_b32 v64, v16
    v_perm_b32 v16, v74, v66, s61
    v_perm_b32 v74, v74, v66, s62
    v_mov_b32 v66, v16
    v_perm_b32 v16, v76, v68, s61
    v_perm_b32 v76, v76, v68, s62
    v_mov_b32 v68, v16
    v_perm_b32 v16, v78, v70, s61
    v_perm_b32 v78, v78, v70, s62
    v_mov_b32 v70, v16
    buffer_load_dword v113, v19, s[48:51], s15 offen offset:0 sc1
    buffer_load_dword v121, v19, s[48:51], s15 offen offset:1280 sc1
    buffer_load_dword v115, v19, s[48:51], s15 offen offset:2560 sc1
    buffer_load_dword v123, v19, s[48:51], s15 offen offset:3840 sc1
    buffer_load_dword v117, v58, s[48:51], s15 offen offset:0 sc1
    buffer_load_dword v125, v58, s[48:51], s15 offen offset:1280 sc1
    buffer_load_dword v119, v58, s[48:51], s15 offen offset:2560 sc1
    buffer_load_dword v127, v58, s[48:51], s15 offen offset:3840 sc1
    s_waitcnt vmcnt(48)
    v_perm_b32 v16, v104, v96, s61
    v_perm_b32 v104, v104, v96, s62
    v_mov_b32 v96, v16
    v_perm_b32 v16, v106, v98, s61
    v_perm_b32 v106, v106, v98, s62
    v_mov_b32 v98, v16
    v_perm_b32 v16, v108, v100, s61
    v_perm_b32 v108, v108, v100, s62
    v_mov_b32 v100, v16
    v_perm_b32 v16, v110, v102, s61
    v_perm_b32 v110, v110, v102, s62
    v_mov_b32 v102, v16
    s_waitcnt vmcnt(40)
    v_perm_b32 v16, v73, v65, s61
    v_perm_b32 v73, v73, v65, s62
    v_mov_b32 v65, v16
    v_perm_b32 v16, v75, v67, s61
    v_perm_b32 v75, v75, v67, s62
    v_mov_b32 v67, v16
    v_perm_b32 v16, v77, v69, s61
    v_perm_b32 v77, v77, v69, s62
    v_mov_b32 v69, v16
    v_perm_b32 v16, v79, v71, s61
    v_perm_b32 v79, v79, v71, s62
    v_mov_b32 v71, v16
    s_waitcnt vmcnt(32)
    v_perm_b32 v16, v105, v97, s61
    v_perm_b32 v105, v105, v97, s62
    v_mov_b32 v97, v16
    v_perm_b32 v16, v107, v99, s61
    v_perm_b32 v107, v107, v99, s62
    v_mov_b32 v99, v16
    v_perm_b32 v16, v109, v101, s61
    v_perm_b32 v109, v109, v101, s62
    v_mov_b32 v101, v16
    v_perm_b32 v16, v111, v103, s61
    v_perm_b32 v111, v111, v103, s62
    v_mov_b32 v103, v16
    s_waitcnt vmcnt(24)
    v_perm_b32 v16, v88, v80, s61
    v_perm_b32 v88, v88, v80, s62
    v_mov_b32 v80, v16
    v_perm_b32 v16, v90, v82, s61
    v_perm_b32 v90, v90, v82, s62
    v_mov_b32 v82, v16
    v_perm_b32 v16, v92, v84, s61
    v_perm_b32 v92, v92, v84, s62
    v_mov_b32 v84, v16
    v_perm_b32 v16, v94, v86, s61
    v_perm_b32 v94, v94, v86, s62
    v_mov_b32 v86, v16
    s_waitcnt vmcnt(16)
    v_perm_b32 v16, v120, v112, s61
    v_perm_b32 v120, v120, v112, s62
    v_mov_b32 v112, v16
    v_perm_b32 v16, v122, v114, s61
    v_perm_b32 v122, v122, v114, s62
    v_mov_b32 v114, v16
    v_perm_b32 v16, v124, v116, s61
    v_perm_b32 v124, v124, v116, s62
    v_mov_b32 v116, v16
    v_perm_b32 v16, v126, v118, s61
    v_perm_b32 v126, v126, v118, s62
    v_mov_b32 v118, v16
    s_waitcnt vmcnt(8)
    v_perm_b32 v16, v89, v81, s61
    v_perm_b32 v89, v89, v81, s62
    v_mov_b32 v81, v16
    v_perm_b32 v16, v91, v83, s61
    v_perm_b32 v91, v91, v83, s62
    v_mov_b32 v83, v16
    v_perm_b32 v16, v93, v85, s61
    v_perm_b32 v93, v93, v85, s62
    v_mov_b32 v85, v16
    v_perm_b32 v16, v95, v87, s61
    v_perm_b32 v95, v95, v87, s62
    v_mov_b32 v87, v16
    s_waitcnt vmcnt(0)
    v_perm_b32 v16, v121, v113, s61
    v_perm_b32 v121, v121, v113, s62
    v_mov_b32 v113, v16
    v_perm_b32 v16, v123, v115, s61
    v_perm_b32 v123, v123, v115, s62
    v_mov_b32 v115, v16
    v_perm_b32 v16, v125, v117, s61
    v_perm_b32 v125, v125, v117, s62
    v_mov_b32 v117, v16
    v_perm_b32 v16, v127, v119, s61
    v_perm_b32 v127, v127, v119, s62
    v_mov_b32 v119, v16
    v_mov_b32 v16, 0
    ds_read_b32 v16, v16 offset:384
    s_and_b32 s10, s2, 3
    s_lshl_b32 s10, s10, 2
    s_waitcnt lgkmcnt(0)
    v_readfirstlane_b32 s27, v16
    s_lshr_b32 s10, s27, s10
    s_and_b32 s10, s10, 4
    s_lshl_b32 s10, s10, 11
    s_add_u32 s14, s14, s10
    s_branch L_pg_261
.p2align 12,,960
L_pg_261:
    s_mov_b32 s60, 200000
L_poll_262:
    buffer_load_dword v14, v10, s[40:43], s13 offen sc1
    buffer_load_dword v15, v10, s[40:43], s13 offen offset:32 sc1
    s_waitcnt vmcnt(0)
    v_max_u32 v16, v14, v15
    v_cmp_eq_u32 vcc, -1, v16
    s_cbranch_vccz L_got_263
    s_sub_u32 s60, s60, 1
    s_cbranch_scc0 L_poll_262
L_got_263:
    v_lshrrev_b32 v14, v11, v14
    v_lshrrev_b32 v15, v11, v15
    v_lshlrev_b32 v14, 16, v14
    v_lshlrev_b32 v15, 16, v15
    s_mov_b32 s16, 0x00ff00ff
    s_mov_b32 s17, 0xff00ff00
    s_mov_b32 s18, 0x000f000f
    s_mov_b32 s19, 0x000f000f
    v_mov_b32 v24, 0
    v_mov_b32 v25, 0
    v_mov_b32 v26, 0
    v_mov_b32 v27, 0
    v_mov_b32 v28, 0
    v_mov_b32 v29, 0
    v_mov_b32 v30, 0
    v_mov_b32 v31, 0
    v_mov_b32 v32, 0
    v_mov_b32 v33, 0
    v_mov_b32 v34, 0
    v_mov_b32 v35, 0
    v_mov_b32 v36, 0
    v_mov_b32 v37, 0
    v_mov_b32 v38, 0
    v_mov_b32 v39, 0
    s_mov_b32 s60, 200000
    buffer_load_dwordx4 v[56:59], v6, s[40:43], s14 offen sc1
    buffer_load_dwordx4 v[60:63], v7, s[40:43], s14 offen sc1
    s_sleep 2
L_poll_264:
    buffer_load_dwordx4 v[128:131], v6, s[40:43], s14 offen sc1
    buffer_load_dwordx4 v[132:135], v7, s[40:43], s14 offen sc1
    s_sub_u32 s60, s60, 1
    s_cbranch_scc1 L_end
    s_waitcnt vmcnt(2)
    v_max_u32 v16, v56, v57
    v_max3_u32 v16, v16, v58, v59
    v_max3_u32 v16, v16, v60, v61
    v_max3_u32 v16, v16, v62, v63
    v_cmp_eq_u32 vcc, -1, v16
    s_cbranch_vccz L_gotA_265
    buffer_load_dwordx4 v[56:59], v6, s[40:43], s14 offen sc1
    buffer_load_dwordx4 v[60:63], v7, s[40:43], s14 offen sc1
    s_waitcnt vmcnt(2)
    v_max_u32 v16, v128, v129
    v_max3_u32 v16, v16, v130, v131
    v_max3_u32 v16, v16, v132, v133
    v_max3_u32 v16, v16, v134, v135
    v_cmp_eq_u32 vcc, -1, v16
    s_cbranch_vccnz L_poll_264
    v_smfmac_f32_16x16x64_bf16 v[24:27], v[128:131], v[64:71], v18
    v_smfmac_f32_16x16x64_bf16 v[28:31], v[128:131], v[72:79], v18
    v_smfmac_f32_16x16x64_bf16 v[32:35], v[128:131], v[80:87], v18
    v_smfmac_f32_16x16x64_bf16 v[36:39], v[128:131], v[88:95], v18
    v_smfmac_f32_16x16x64_bf16 v[24:27], v[132:135], v[96:103], v18
    v_smfmac_f32_16x16x64_bf16 v[28:31], v[132:135], v[104:111], v18
    v_smfmac_f32_16x16x64_bf16 v[32:35], v[132:135], v[112:119], v18
    v_smfmac_f32_16x16x64_bf16 v[36:39], v[132:135], v[120:127], v18
    s_branch L_got_266
L_gotA_265:
    v_smfmac_f32_16x16x64_bf16 v[24:27], v[56:59], v[64:71], v18
    v_smfmac_f32_16x16x64_bf16 v[28:31], v[56:59], v[72:79], v18
    v_smfmac_f32_16x16x64_bf16 v[32:35], v[56:59], v[80:87], v18
    v_smfmac_f32_16x16x64_bf16 v[36:39], v[56:59], v[88:95], v18
    v_smfmac_f32_16x16x64_bf16 v[24:27], v[60:63], v[96:103], v18
    v_smfmac_f32_16x16x64_bf16 v[28:31], v[60:63], v[104:111], v18
    v_smfmac_f32_16x16x64_bf16 v[32:35], v[60:63], v[112:119], v18
    v_smfmac_f32_16x16x64_bf16 v[36:39], v[60:63], v[120:127], v18
L_got_266:
    s_mov_b64 exec, s[16:17]
    s_cmp_eq_u32 s3, 0
    s_nop 2
    v_add_f32 v16, v24, v25
    v_add_f32 v17, v28, v29
    v_add_f32 v16, v16, v34
    v_add_f32 v16, v16, v35
    v_add_f32 v17, v17, v38
    v_add_f32 v17, v17, v39
    ds_write_b64 v12, v[16:17]
    s_mov_b64 exec, -1
    s_waitcnt lgkmcnt(0)
    s_barrier
    s_cbranch_scc0 L_dend
    ds_read2_b64 v[24:27], v13 offset0:0 offset1:16
    s_waitcnt lgkmcnt(0)
    v_pk_add_f32 v[24:25], v[24:25], v[26:27]
    s_nop 1
    v_add_f32_dpp v24, v24, v24 row_ror:8 row_mask:0xf bank_mask:0xf
    v_add_f32_dpp v25, v25, v25 row_ror:8 row_mask:0xf bank_mask:0xf
    s_nop 0
    v_add_f32_dpp v24, v24, v24 row_ror:4 row_mask:0xf bank_mask:0xf
    v_add_f32_dpp v25, v25, v25 row_ror:4 row_mask:0xf bank_mask:0xf
    v_pk_add_f32 v[14:15], v[14:15], v[24:25]
    s_mov_b64 exec, s[18:19]
    v_cvt_pk_bf16_f32 v16, v14, v15
    buffer_store_dword v16, v9, s[52:55], 0 offen
L_dend:
L_end:
    s_endpgm
L_hslow:
    buffer_store_dword v16, v13, s[40:43], s53 offen sc1
    s_branch L_hdone
L_mls_174:
    buffer_store_dwordx2 v[20:21], v2, s[40:43], 0 offen sc1
    s_branch L_mlz_175
L_nw4_182:
    s_barrier
    s_branch L_e_165
L_slow_180:
    buffer_store_dword v22, v1, s[40:43], 0 offen sc1
    s_branch L_e_165
L_mls_199:
    buffer_store_dwordx2 v[20:21], v2, s[40:43], 0 offen sc1
    s_branch L_mlz_200
L_nw4_207:
    s_barrier
    s_branch L_e_188
L_slow_205:
    buffer_store_dword v22, v1, s[40:43], 0 offen sc1
    s_branch L_e_188
L_mls_225:
    buffer_store_dwordx2 v[20:21], v2, s[40:43], 0 offen sc1
    s_branch L_mlz_226
L_nw4_233:
    s_barrier
    s_branch L_e_216
L_slow_231:
    buffer_store_dword v22, v1, s[40:43], 0 offen sc1
    s_branch L_e_216
L_mls_252:
    buffer_store_dwordx2 v[20:21], v2, s[40:43], 0 offen sc1
    s_branch L_mlz_253
L_nw4_260:
    s_barrier
    s_branch L_e_243
L_slow_258:
    buffer_store_dword v22, v1, s[40:43], 0 offen sc1
    s_branch L_e_243
.section .rodata,"a"
.p2align 6
.amdhsa_kernel sequential_preLN__mha_block_cached__geglu_ffn__decode_kernel
  .amdhsa_next_free_vgpr 248
  .amdhsa_next_free_sgpr 64
  .amdhsa_accum_offset 248
  .amdhsa_group_segment_fixed_size 0
  .amdhsa_kernarg_size 96
  .amdhsa_user_sgpr_count 2
  .amdhsa_user_sgpr_kernarg_segment_ptr 1
  .amdhsa_system_sgpr_workgroup_id_x 1
  .amdhsa_float_denorm_mode_32 3
.end_amdhsa_kernel
```
